```python
import torch

def _softmax(x, axis=-1):
    return torch.softmax(x, dim=axis)
def _gelu(x):
    return torch.nn.functional.gelu(x, approximate="tanh")
def _silu(x):
    return torch.nn.functional.silu(x)
def _sigmoid(x):
    return torch.sigmoid(x)
def _layernorm(x, axis=-1, eps=1e-5):
    m = x.mean(dim=axis, keepdim=True)
    v = x.var(dim=axis, keepdim=True, unbiased=False)
    return (x - m) / torch.sqrt(v + eps)
def _scatter_add(tgt, idx, src, axis=0):
    return tgt.clone().index_add_(axis, idx, src)
def _segment_sum(src, seg, n):
    out = torch.zeros((n,) + src.shape[1:], dtype=src.dtype)
    return out.index_add_(0, seg, src)
def _pad(x, pw):
    flat = tuple(v for pair in reversed(pw) for v in pair)
    return torch.nn.functional.pad(x, flat)

kernel_name = 'recurrent_scan__grouped_kv_mqa__glu_gated_reglu__prompt'

def setup_inputs():

    _w = (lambda a: (lambda t: t.to(torch.bfloat16) if t.is_floating_point() else t)(torch.as_tensor(a)))
    def _A_setup():
        B, S, D, H = 1, 2048, 512, 32
        Dh = D // H
        return {
            "x": _w((lambda *s: torch.randn(*s, dtype=torch.bfloat16) * 0.05)(B, S, D)),
            "wq": _w((lambda *s: torch.randn(*s, dtype=torch.bfloat16) * 0.2)(D, H * Dh)),
            "wk": _w((lambda *s: torch.randn(*s, dtype=torch.bfloat16) * 0.2)(D, Dh)),
            "wv": _w((lambda *s: torch.randn(*s, dtype=torch.bfloat16) * 0.2)(D, Dh)),
            "wo": _w((lambda *s: torch.randn(*s, dtype=torch.bfloat16) * 0.2)(H * Dh, D)),
        }
    _A_in = _A_setup()

    def _B_setup():
        B, S, D, F = 1, 2048, 512, 1792
        return {
            "x": _w((lambda *s: torch.randn(*s, dtype=torch.bfloat16) * 0.05)(B, S, D)),
            "W_gate": _w((lambda *s: torch.randn(*s, dtype=torch.bfloat16) * 0.1)(D, F) * (2.0 / D) ** 0.5),
            "W_up": _w((lambda *s: torch.randn(*s, dtype=torch.bfloat16) * 0.1)(D, F) * (2.0 / D) ** 0.5),
            "W_down": _w((lambda *s: torch.randn(*s, dtype=torch.bfloat16) * 0.1)(F, D) * (1.0 / F) ** 0.5),
        }
    _B_in = _B_setup()

    return {
        "A_x": _A_in["x"],
        "A_wq": _A_in["wq"],
        "A_wk": _A_in["wk"],
        "A_wv": _A_in["wv"],
        "A_wo": _A_in["wo"],
        "B_x": _B_in["x"],
        "B_W_gate": _B_in["W_gate"],
        "B_W_up": _B_in["W_up"],
        "B_W_down": _B_in["W_down"],
    }

def reference(A_x, A_wq, A_wk, A_wv, A_wo, B_x, B_W_gate, B_W_up, B_W_down):
    def _A_ref(x, wq, wk, wv, wo):
        B, S, D = x.shape
        H = 32
        Dh = D // H
        q = (lambda x, *d: x.permute(*d))((x @ wq).reshape(B, S, H, Dh), 0, 2, 1, 3)
        k = x @ wk
        v = x @ wv
        scores = torch.einsum("bhqd,bkd->bhqk", q, k) * (Dh ** -0.5)
        p = _softmax(scores, axis=-1)
        o = torch.einsum("bhqk,bkd->bhqd", p, v)
        return (lambda x, *d: x.permute(*d))(o, 0, 2, 1, 3).reshape(B, S, H * Dh) @ wo

    def _B_ref(x, W_gate, W_up, W_down):
        gate = torch.einsum("bsd,df->bsf", x, W_gate)
        up = torch.einsum("bsd,df->bsf", x, W_up)
        gate = gate * (lambda x, dt: x.to(dt))(gate > 0, gate.dtype)
        h = gate * up
        return torch.einsum("bsf,fd->bsd", h, W_down)

    x = A_x
    xn = _layernorm(x, axis=-1)
    s = _A_ref(xn, A_wq, A_wk, A_wv, A_wo)
    g = _silu(_B_ref(xn, B_W_gate, B_W_up, B_W_down))
    return x + s * g
```

```asm
; @launch grid=(256,1,1) block=(768,1,1) lds=163840
.amdgcn_target "amdgcn-amd-amdhsa--gfx950"
.text
.globl recurrent_scan__grouped_kv_mqa__glu_gated_reglu__prompt_kernel
.p2align 8
.type recurrent_scan__grouped_kv_mqa__glu_gated_reglu__prompt_kernel,@function
recurrent_scan__grouped_kv_mqa__glu_gated_reglu__prompt_kernel:
    s_cmp_ge_u32 s2, 256
    s_cbranch_scc1 .Lend
    s_load_dwordx16 s[4:19], s[0:1], 0
    s_load_dwordx8 s[20:27], s[0:1], 64
    v_lshrrev_b32 v2, 6, v0
    v_and_b32 v1, 63, v0
    s_and_b32 s59, s2, 7
    v_readfirstlane_b32 s56, v2
    s_lshr_b32 s60, s2, 3
    s_and_b32 s57, s59, 1
    s_lshl_b32 s57, s57, 3
    s_and_b32 s61, s60, 7
    s_add_u32 s57, s57, s61
    s_lshr_b32 s58, s59, 1
    s_lshl_b32 s58, s58, 2
    s_lshr_b32 s61, s60, 3
    s_add_u32 s58, s58, s61
    v_lshlrev_b32 v144, 4, v1
    s_mov_b32 s86, 0xffff0000
    s_mov_b32 s30, 2097152
    s_mov_b32 s31, 0x00020000
    s_mov_b32 s42, 18874368
    s_mov_b32 s43, 0x00020000
    s_cmp_ge_u32 s56, 8
    s_cbranch_scc1 .Laux
    v_lshrrev_b32 v2, 3, v1
    v_lshrrev_b32 v3, 4, v1
    v_and_b32 v6, 7, v1
    v_xor_b32 v6, v6, v3
    s_lshl_b32 s59, s57, 7
    s_lshl_b32 s60, s56, 4
    s_add_u32 s59, s59, s60
    s_lshl_b32 s59, s59, 10
    v_lshlrev_b32 v2, 10, v2
    v_add_u32 v2, s59, v2
    v_lshl_add_u32 v4, v6, 4, v2
    v_xor_b32 v6, 4, v6
    v_lshl_add_u32 v5, v6, 4, v2
    v_add_u32 v5, 0x2000, v5
    s_lshl_b32 s64, s56, 11
    s_add_u32 s65, s64, 1024
    s_mov_b32 s35, 0x00020000
    s_mov_b32 s39, 0x00020000
    s_cmp_eq_u32 s56, 7
    s_cbranch_scc1 .Lsetupq
    s_mul_i32 s83, s58, 224
    s_movk_i32 s84, 4682
    s_movk_i32 s85, 3360
    s_lshl_b32 s59, s56, 2
    s_add_u32 s59, s59, 0
    s_cmp_lt_u32 s59, 14
    s_cselect_b32 s60, 0, 14
    s_cselect_b32 s61, 0, 14464
    s_sub_u32 s59, s59, s60
    s_add_u32 s61, s61, 49152
    s_lshl_b32 s60, s59, 10
    s_add_u32 s66, s61, s60
    s_lshl_b32 s59, s59, 6
    v_add_u32 v2, s59, v1
    v_mul_u32_u24 v3, s84, v2
    v_lshrrev_b32 v3, 16, v3
    v_lshl_add_u32 v6, v2, 4, s83
    v_mad_u32_u24 v12, v3, s85, v6
    s_lshl_b32 s59, s56, 2
    s_add_u32 s59, s59, 1
    s_cmp_lt_u32 s59, 14
    s_cselect_b32 s60, 0, 14
    s_cselect_b32 s61, 0, 14464
    s_sub_u32 s59, s59, s60
    s_add_u32 s61, s61, 49152
    s_lshl_b32 s60, s59, 10
    s_add_u32 s67, s61, s60
    s_lshl_b32 s59, s59, 6
    v_add_u32 v2, s59, v1
    v_mul_u32_u24 v3, s84, v2
    v_lshrrev_b32 v3, 16, v3
    v_lshl_add_u32 v6, v2, 4, s83
    v_mad_u32_u24 v13, v3, s85, v6
    s_lshl_b32 s59, s56, 2
    s_add_u32 s59, s59, 2
    s_cmp_lt_u32 s59, 14
    s_cselect_b32 s60, 0, 14
    s_cselect_b32 s61, 0, 14464
    s_sub_u32 s59, s59, s60
    s_add_u32 s61, s61, 49152
    s_lshl_b32 s60, s59, 10
    s_add_u32 s68, s61, s60
    s_lshl_b32 s59, s59, 6
    v_add_u32 v2, s59, v1
    v_mul_u32_u24 v3, s84, v2
    v_lshrrev_b32 v3, 16, v3
    v_lshl_add_u32 v6, v2, 4, s83
    v_mad_u32_u24 v14, v3, s85, v6
    s_lshl_b32 s59, s56, 2
    s_add_u32 s59, s59, 3
    s_cmp_lt_u32 s59, 14
    s_cselect_b32 s60, 0, 14
    s_cselect_b32 s61, 0, 14464
    s_sub_u32 s59, s59, s60
    s_add_u32 s61, s61, 49152
    s_lshl_b32 s60, s59, 10
    s_add_u32 s69, s61, s60
    s_lshl_b32 s59, s59, 6
    v_add_u32 v2, s59, v1
    v_mul_u32_u24 v3, s84, v2
    v_lshrrev_b32 v3, 16, v3
    v_lshl_add_u32 v6, v2, 4, s83
    v_mad_u32_u24 v15, v3, s85, v6
    s_mov_b32 s34, 1835008
    s_mov_b32 s38, 1835008
    s_mov_b32 s87, 28928
    s_mov_b32 s88, 57856
    s_mov_b32 s89, 229376
    s_waitcnt lgkmcnt(0)
    s_cmp_le_u32 s56, 3
    s_cselect_b32 s32, s16, s18
    s_cselect_b32 s33, s17, s19
    s_cmp_le_u32 s56, 2
    s_cselect_b32 s36, s16, s18
    s_cselect_b32 s37, s17, s19
    s_mov_b32 s28, s4
    s_mov_b32 s29, s5
    s_mov_b32 s40, s26
    s_mov_b32 s41, s27
    s_cmp_lt_u32 s56, 2
    s_cbranch_scc1 .LvarB
    s_branch .LvarA
.Lsetupq:
    s_lshl_b32 s83, s58, 6
    v_lshrrev_b32 v3, 2, v1
    v_and_b32 v6, 3, v1
    v_lshlrev_b32 v3, 10, v3
    v_lshl_add_u32 v3, v6, 4, v3
    v_add_u32 v3, s83, v3
    v_add_u32 v12, 0, v3
    s_mov_b32 s66, 135936
    v_add_u32 v13, 16384, v3
    s_mov_b32 s67, 136960
    v_add_u32 v14, 32768, v3
    s_mov_b32 s68, 137984
    v_add_u32 v15, 49152, v3
    s_mov_b32 s69, 139008
    s_mov_b32 s34, 524288
    s_mov_b32 s38, 524288
    s_mov_b32 s87, 4096
    s_mov_b32 s88, 8192
    s_mov_b32 s89, 65536
    s_waitcnt lgkmcnt(0)
    s_mov_b32 s32, s6
    s_mov_b32 s33, s7
    s_mov_b32 s36, s6
    s_mov_b32 s37, s7
    s_mov_b32 s28, s4
    s_mov_b32 s29, s5
    s_mov_b32 s40, s26
    s_mov_b32 s41, s27
.LvarA:
    s_mov_b32 s91, s57
    s_add_u32 s63, s91, 0
    s_and_b32 s63, s63, 7
    s_lshl_b32 s60, s63, 7
    s_mul_i32 s61, s89, s63
    s_add_u32 m0, s64, 0
    s_nop 0
    buffer_load_dwordx4 v4, s[28:31], s60 offen lds
    s_add_u32 m0, s65, 0
    s_nop 0
    buffer_load_dwordx4 v5, s[28:31], s60 offen lds
    s_add_u32 m0, s66, 0
    s_nop 0
    buffer_load_dwordx4 v12, s[32:35], s61 offen lds
    s_add_u32 m0, s67, 0
    s_nop 0
    buffer_load_dwordx4 v13, s[32:35], s61 offen lds
    s_add_u32 m0, s68, 0
    s_nop 0
    buffer_load_dwordx4 v14, s[36:39], s61 offen lds
    s_add_u32 m0, s69, 0
    s_nop 0
    buffer_load_dwordx4 v15, s[36:39], s61 offen lds
    s_add_u32 s92, s26, 2031616
    s_addc_u32 s93, s27, 0
    s_load_dword s90, s[92:93], 0
    s_and_b32 s70, s56, 1
    s_lshr_b32 s71, s56, 1
    s_add_u32 s71, s71, 3
    s_and_b32 s71, s71, 3
    s_lshr_b32 s72, s57, 3
    s_lshl_b32 s72, s72, 1
    s_add_u32 s72, s72, s70
    v_and_b32 v2, 31, v1
    v_lshrrev_b32 v3, 5, v1
    v_lshrrev_b32 v6, 1, v2
    v_and_b32 v6, 7, v6
    v_xor_b32 v6, v6, v3
    s_lshl_b32 s59, s70, 13
    v_lshlrev_b32 v7, 7, v2
    v_add_u32 v7, s59, v7
    v_lshl_add_u32 v7, v6, 4, v7
    s_xor_b32 s59, s72, 0
    s_lshl_b32 s59, s59, 5
    v_xor_b32 v48, s59, v7
    s_xor_b32 s59, s72, 1
    s_lshl_b32 s59, s59, 5
    v_xor_b32 v49, s59, v7
    s_xor_b32 s59, s72, 2
    s_lshl_b32 s59, s59, 5
    v_xor_b32 v50, s59, v7
    s_xor_b32 s59, s72, 3
    s_lshl_b32 s59, s59, 5
    v_xor_b32 v51, s59, v7
    s_barrier
    s_add_u32 s63, s91, 1
    s_and_b32 s63, s63, 7
    s_lshl_b32 s60, s63, 7
    s_mul_i32 s61, s89, s63
    s_add_u32 m0, s64, 16384
    s_nop 0
    buffer_load_dwordx4 v4, s[28:31], s60 offen lds
    v_and_b32 v6, 1, v1
    v_lshlrev_b32 v6, 1, v6
    v_bfe_u32 v7, v1, 1, 1
    v_or_b32 v6, v6, v7
    v_bfe_u32 v7, v1, 2, 2
    v_lshl_add_u32 v7, v3, 3, v7
    v_bfe_u32 v8, v1, 4, 1
    s_add_u32 m0, s65, 16384
    s_nop 0
    buffer_load_dwordx4 v5, s[28:31], s60 offen lds
    v_mul_u32_u24 v9, 224, v7
    v_lshl_add_u32 v9, v6, 3, v9
    v_mul_u32_u24 v11, 14464, v8
    v_add_u32 v9, v9, v11
    s_lshl_b32 s59, s71, 6
    s_add_u32 s59, s59, 49152
    v_add_u32 v9, s59, v9
    s_add_u32 m0, s66, s87
    s_nop 0
    buffer_load_dwordx4 v12, s[32:35], s61 offen lds
    s_xor_b32 s59, s72, 0
    s_mul_i32 s62, s59, 3584
    v_add_u32 v52, s62, v9
    s_xor_b32 s59, s72, 1
    s_mul_i32 s62, s59, 3584
    v_add_u32 v53, s62, v9
    s_xor_b32 s59, s72, 2
    s_mul_i32 s62, s59, 3584
    v_add_u32 v54, s62, v9
    s_xor_b32 s59, s72, 3
    s_mul_i32 s62, s59, 3584
    v_add_u32 v55, s62, v9
    s_add_u32 m0, s67, s87
    s_nop 0
    buffer_load_dwordx4 v13, s[32:35], s61 offen lds
    v_and_b32 v7, 15, v1
    v_lshlrev_b32 v8, 2, v8
    v_cmp_eq_u32 vcc, v7, v8
    v_mov_b32 v9, 0x3f803f80
    s_nop 0
    v_cndmask_b32 v136, 0, v9, vcc
    v_cndmask_b32 v137, 0, v9, vcc
    v_cndmask_b32 v138, 0, v9, vcc
    v_cndmask_b32 v139, 0, v9, vcc
    s_lshl_b32 s59, s56, 8
    s_add_u32 s59, s59, 148480
    v_lshl_add_u32 v60, v2, 3, s59
    s_lshr_b32 s59, s56, 1
    s_lshl_b32 s59, s59, 9
    s_add_u32 s59, s59, 148480
    v_lshl_add_u32 v61, v2, 4, s59
    v_mov_b32 v7, 160384
    v_cmp_gt_u32 vcc, 32, v1
    s_lshl_b32 s59, s70, 9
    s_add_u32 s59, s59, 150528
    v_cndmask_b32 v61, v7, v61, vcc
    v_lshl_add_u32 v62, v2, 3, s59
    v_mov_b32 v150, 0
    v_mov_b32 v151, 0
    v_mov_b32 v154, 0
    v_mov_b32 v155, 0
    v_mov_b32 v158, 0
    v_mov_b32 v159, 0
    v_mov_b32 v162, 0
    v_mov_b32 v163, 0
    s_waitcnt lgkmcnt(0)
    s_mul_i32 s90, s90, 0x9e3779b1
    s_add_u32 s90, s90, 0x7f4a7c15
    s_waitcnt vmcnt(4)
    s_barrier
    ds_read_b128 v[16:19], v48 offset:0
    ds_read_b128 v[20:23], v48 offset:4096
    ds_read_b64_tr_b16 v[32:33], v52 offset:0
    ds_read_b64_tr_b16 v[34:35], v52 offset:896
    ds_read_b64_tr_b16 v[36:37], v52 offset:32
    ds_read_b64_tr_b16 v[38:39], v52 offset:928
    s_waitcnt lgkmcnt(0)
    ds_read_b128 v[24:27], v49 offset:0
    ds_read_b128 v[28:31], v49 offset:4096
    ds_read_b64_tr_b16 v[40:41], v53 offset:0
    ds_read_b64_tr_b16 v[42:43], v53 offset:896
    ds_read_b64_tr_b16 v[44:45], v53 offset:32
    ds_read_b64_tr_b16 v[46:47], v53 offset:928
    v_mfma_f32_32x32x16_bf16 v[64:79], v[32:35], v[16:19], 0
    s_add_u32 m0, s68, s87
    s_nop 0
    buffer_load_dwordx4 v14, s[36:39], s61 offen lds
    v_mfma_f32_32x32x16_bf16 v[80:95], v[32:35], v[20:23], 0
    s_add_u32 m0, s69, s87
    s_nop 0
    buffer_load_dwordx4 v15, s[36:39], s61 offen lds
    v_mfma_f32_32x32x16_bf16 v[96:111], v[36:39], v[16:19], 0
    s_add_u32 s63, s91, 2
    s_and_b32 s63, s63, 7
    s_lshl_b32 s60, s63, 7
    s_mul_i32 s61, s89, s63
    s_add_u32 m0, s64, 32768
    s_nop 0
    buffer_load_dwordx4 v4, s[28:31], s60 offen lds
    v_mfma_f32_32x32x16_bf16 v[112:127], v[36:39], v[20:23], 0
    v_mfma_f32_16x16x32_bf16 v[128:131], v[136:139], v[32:35], 0
    v_mfma_f32_16x16x32_bf16 v[132:135], v[136:139], v[36:39], 0
    s_waitcnt lgkmcnt(0)
    ds_read_b128 v[16:19], v50 offset:0
    ds_read_b128 v[20:23], v50 offset:4096
    ds_read_b64_tr_b16 v[32:33], v54 offset:0
    ds_read_b64_tr_b16 v[34:35], v54 offset:896
    ds_read_b64_tr_b16 v[36:37], v54 offset:32
    ds_read_b64_tr_b16 v[38:39], v54 offset:928
    v_mfma_f32_32x32x16_bf16 v[64:79], v[40:43], v[24:27], v[64:79]
    s_add_u32 m0, s65, 32768
    s_nop 0
    buffer_load_dwordx4 v5, s[28:31], s60 offen lds
    v_mfma_f32_32x32x16_bf16 v[80:95], v[40:43], v[28:31], v[80:95]
    s_add_u32 m0, s66, s88
    s_nop 0
    buffer_load_dwordx4 v12, s[32:35], s61 offen lds
    v_mfma_f32_32x32x16_bf16 v[96:111], v[44:47], v[24:27], v[96:111]
    s_add_u32 m0, s67, s88
    s_nop 0
    buffer_load_dwordx4 v13, s[32:35], s61 offen lds
    v_mfma_f32_32x32x16_bf16 v[112:127], v[44:47], v[28:31], v[112:127]
    v_mov_b32 v129, v132
    s_mov_b64 exec, 0xffffffff
    ds_write_b64 v60, v[128:129]
    s_mov_b64 exec, -1
    s_waitcnt lgkmcnt(0)
    ds_read_b128 v[24:27], v51 offset:0
    ds_read_b128 v[28:31], v51 offset:4096
    ds_read_b64_tr_b16 v[40:41], v55 offset:0
    ds_read_b64_tr_b16 v[42:43], v55 offset:896
    ds_read_b64_tr_b16 v[44:45], v55 offset:32
    ds_read_b64_tr_b16 v[46:47], v55 offset:928
    v_mfma_f32_32x32x16_bf16 v[64:79], v[32:35], v[16:19], v[64:79]
    s_add_u32 m0, s68, s88
    s_nop 0
    buffer_load_dwordx4 v14, s[36:39], s61 offen lds
    v_mfma_f32_32x32x16_bf16 v[80:95], v[32:35], v[20:23], v[80:95]
    s_add_u32 m0, s69, s88
    s_nop 0
    buffer_load_dwordx4 v15, s[36:39], s61 offen lds
    v_mfma_f32_32x32x16_bf16 v[96:111], v[36:39], v[16:19], v[96:111]
    v_mfma_f32_32x32x16_bf16 v[112:127], v[36:39], v[20:23], v[112:127]
    s_waitcnt lgkmcnt(0)
    s_waitcnt vmcnt(6)
    s_barrier
    ds_read_b128 v[16:19], v48 offset:16384
    ds_read_b128 v[20:23], v48 offset:20480
    ds_read_b64_tr_b16 v[32:33], v52 offset:28928
    ds_read_b64_tr_b16 v[34:35], v52 offset:29824
    ds_read_b64_tr_b16 v[36:37], v52 offset:28960
    ds_read_b64_tr_b16 v[38:39], v52 offset:29856
    v_mfma_f32_32x32x16_bf16 v[64:79], v[40:43], v[24:27], v[64:79]
    s_add_u32 s63, s91, 3
    s_and_b32 s63, s63, 7
    s_lshl_b32 s60, s63, 7
    s_mul_i32 s61, s89, s63
    s_add_u32 m0, s64, 0
    s_nop 0
    buffer_load_dwordx4 v4, s[28:31], s60 offen lds
    v_mfma_f32_32x32x16_bf16 v[80:95], v[40:43], v[28:31], v[80:95]
    s_add_u32 m0, s65, 0
    s_nop 0
    buffer_load_dwordx4 v5, s[28:31], s60 offen lds
    v_mfma_f32_32x32x16_bf16 v[96:111], v[44:47], v[24:27], v[96:111]
    s_add_u32 m0, s66, 0
    s_nop 0
    buffer_load_dwordx4 v12, s[32:35], s61 offen lds
    v_mfma_f32_32x32x16_bf16 v[112:127], v[44:47], v[28:31], v[112:127]
    s_waitcnt lgkmcnt(0)
    ds_read_b128 v[24:27], v49 offset:16384
    ds_read_b128 v[28:31], v49 offset:20480
    ds_read_b64_tr_b16 v[40:41], v53 offset:28928
    ds_read_b64_tr_b16 v[42:43], v53 offset:29824
    ds_read_b64_tr_b16 v[44:45], v53 offset:28960
    ds_read_b64_tr_b16 v[46:47], v53 offset:29856
    v_mfma_f32_32x32x16_bf16 v[64:79], v[32:35], v[16:19], v[64:79]
    s_add_u32 m0, s67, 0
    s_nop 0
    buffer_load_dwordx4 v13, s[32:35], s61 offen lds
    v_mfma_f32_32x32x16_bf16 v[80:95], v[32:35], v[20:23], v[80:95]
    s_add_u32 m0, s68, 0
    s_nop 0
    buffer_load_dwordx4 v14, s[36:39], s61 offen lds
    v_mfma_f32_32x32x16_bf16 v[96:111], v[36:39], v[16:19], v[96:111]
    s_add_u32 m0, s69, 0
    s_nop 0
    buffer_load_dwordx4 v15, s[36:39], s61 offen lds
    v_mfma_f32_32x32x16_bf16 v[112:127], v[36:39], v[20:23], v[112:127]
    s_waitcnt lgkmcnt(0)
    ds_read_b128 v[16:19], v50 offset:16384
    ds_read_b128 v[20:23], v50 offset:20480
    ds_read_b64_tr_b16 v[32:33], v54 offset:28928
    ds_read_b64_tr_b16 v[34:35], v54 offset:29824
    ds_read_b64_tr_b16 v[36:37], v54 offset:28960
    ds_read_b64_tr_b16 v[38:39], v54 offset:29856
    v_mfma_f32_32x32x16_bf16 v[64:79], v[40:43], v[24:27], v[64:79]
    v_mfma_f32_32x32x16_bf16 v[80:95], v[40:43], v[28:31], v[80:95]
    v_mfma_f32_32x32x16_bf16 v[96:111], v[44:47], v[24:27], v[96:111]
    v_mfma_f32_32x32x16_bf16 v[112:127], v[44:47], v[28:31], v[112:127]
    s_waitcnt lgkmcnt(0)
    ds_read_b128 v[24:27], v51 offset:16384
    ds_read_b128 v[28:31], v51 offset:20480
    ds_read_b64_tr_b16 v[40:41], v55 offset:28928
    ds_read_b64_tr_b16 v[42:43], v55 offset:29824
    ds_read_b64_tr_b16 v[44:45], v55 offset:28960
    ds_read_b64_tr_b16 v[46:47], v55 offset:29856
    v_mfma_f32_32x32x16_bf16 v[64:79], v[32:35], v[16:19], v[64:79]
    v_mfma_f32_32x32x16_bf16 v[80:95], v[32:35], v[20:23], v[80:95]
    v_mfma_f32_32x32x16_bf16 v[96:111], v[36:39], v[16:19], v[96:111]
    v_mfma_f32_32x32x16_bf16 v[112:127], v[36:39], v[20:23], v[112:127]
    s_waitcnt lgkmcnt(0)
    s_waitcnt vmcnt(6)
    s_barrier
    ds_read_b128 v[16:19], v48 offset:32768
    ds_read_b128 v[20:23], v48 offset:36864
    ds_read_b64_tr_b16 v[32:33], v52 offset:57856
    ds_read_b64_tr_b16 v[34:35], v52 offset:58752
    ds_read_b64_tr_b16 v[36:37], v52 offset:57888
    ds_read_b64_tr_b16 v[38:39], v52 offset:58784
    v_mfma_f32_32x32x16_bf16 v[64:79], v[40:43], v[24:27], v[64:79]
    s_add_u32 s63, s91, 4
    s_and_b32 s63, s63, 7
    s_lshl_b32 s60, s63, 7
    s_mul_i32 s61, s89, s63
    s_add_u32 m0, s64, 16384
    s_nop 0
    buffer_load_dwordx4 v4, s[28:31], s60 offen lds
    v_mfma_f32_32x32x16_bf16 v[80:95], v[40:43], v[28:31], v[80:95]
    s_add_u32 m0, s65, 16384
    s_nop 0
    buffer_load_dwordx4 v5, s[28:31], s60 offen lds
    v_mfma_f32_32x32x16_bf16 v[96:111], v[44:47], v[24:27], v[96:111]
    s_add_u32 m0, s66, s87
    s_nop 0
    buffer_load_dwordx4 v12, s[32:35], s61 offen lds
    v_mfma_f32_32x32x16_bf16 v[112:127], v[44:47], v[28:31], v[112:127]
    s_waitcnt lgkmcnt(0)
    ds_read_b128 v[24:27], v49 offset:32768
    ds_read_b128 v[28:31], v49 offset:36864
    ds_read_b64_tr_b16 v[40:41], v53 offset:57856
    ds_read_b64_tr_b16 v[42:43], v53 offset:58752
    ds_read_b64_tr_b16 v[44:45], v53 offset:57888
    ds_read_b64_tr_b16 v[46:47], v53 offset:58784
    v_mfma_f32_32x32x16_bf16 v[64:79], v[32:35], v[16:19], v[64:79]
    s_add_u32 m0, s67, s87
    s_nop 0
    buffer_load_dwordx4 v13, s[32:35], s61 offen lds
    v_mfma_f32_32x32x16_bf16 v[80:95], v[32:35], v[20:23], v[80:95]
    s_add_u32 m0, s68, s87
    s_nop 0
    buffer_load_dwordx4 v14, s[36:39], s61 offen lds
    v_mfma_f32_32x32x16_bf16 v[96:111], v[36:39], v[16:19], v[96:111]
    s_add_u32 m0, s69, s87
    s_nop 0
    buffer_load_dwordx4 v15, s[36:39], s61 offen lds
    v_mfma_f32_32x32x16_bf16 v[112:127], v[36:39], v[20:23], v[112:127]
    s_waitcnt lgkmcnt(0)
    ds_read_b128 v[16:19], v50 offset:32768
    ds_read_b128 v[20:23], v50 offset:36864
    ds_read_b64_tr_b16 v[32:33], v54 offset:57856
    ds_read_b64_tr_b16 v[34:35], v54 offset:58752
    ds_read_b64_tr_b16 v[36:37], v54 offset:57888
    ds_read_b64_tr_b16 v[38:39], v54 offset:58784
    v_mfma_f32_32x32x16_bf16 v[64:79], v[40:43], v[24:27], v[64:79]
    v_mfma_f32_32x32x16_bf16 v[80:95], v[40:43], v[28:31], v[80:95]
    v_mfma_f32_32x32x16_bf16 v[96:111], v[44:47], v[24:27], v[96:111]
    v_mfma_f32_32x32x16_bf16 v[112:127], v[44:47], v[28:31], v[112:127]
    s_waitcnt lgkmcnt(0)
    ds_read_b128 v[24:27], v51 offset:32768
    ds_read_b128 v[28:31], v51 offset:36864
    ds_read_b64_tr_b16 v[40:41], v55 offset:57856
    ds_read_b64_tr_b16 v[42:43], v55 offset:58752
    ds_read_b64_tr_b16 v[44:45], v55 offset:57888
    ds_read_b64_tr_b16 v[46:47], v55 offset:58784
    v_mfma_f32_32x32x16_bf16 v[64:79], v[32:35], v[16:19], v[64:79]
    v_mfma_f32_32x32x16_bf16 v[80:95], v[32:35], v[20:23], v[80:95]
    v_mfma_f32_32x32x16_bf16 v[96:111], v[36:39], v[16:19], v[96:111]
    v_mfma_f32_32x32x16_bf16 v[112:127], v[36:39], v[20:23], v[112:127]
    s_waitcnt lgkmcnt(0)
    s_waitcnt vmcnt(6)
    s_barrier
    ds_read_b128 v[16:19], v48 offset:0
    ds_read_b128 v[20:23], v48 offset:4096
    ds_read_b64_tr_b16 v[32:33], v52 offset:0
    ds_read_b64_tr_b16 v[34:35], v52 offset:896
    ds_read_b64_tr_b16 v[36:37], v52 offset:32
    ds_read_b64_tr_b16 v[38:39], v52 offset:928
    v_mfma_f32_32x32x16_bf16 v[64:79], v[40:43], v[24:27], v[64:79]
    s_add_u32 s63, s91, 5
    s_and_b32 s63, s63, 7
    s_lshl_b32 s60, s63, 7
    s_mul_i32 s61, s89, s63
    s_add_u32 m0, s64, 32768
    s_nop 0
    buffer_load_dwordx4 v4, s[28:31], s60 offen lds
    v_mfma_f32_32x32x16_bf16 v[80:95], v[40:43], v[28:31], v[80:95]
    s_add_u32 m0, s65, 32768
    s_nop 0
    buffer_load_dwordx4 v5, s[28:31], s60 offen lds
    v_mfma_f32_32x32x16_bf16 v[96:111], v[44:47], v[24:27], v[96:111]
    s_add_u32 m0, s66, s88
    s_nop 0
    buffer_load_dwordx4 v12, s[32:35], s61 offen lds
    v_mfma_f32_32x32x16_bf16 v[112:127], v[44:47], v[28:31], v[112:127]
    s_waitcnt lgkmcnt(0)
    ds_read_b128 v[24:27], v49 offset:0
    ds_read_b128 v[28:31], v49 offset:4096
    ds_read_b64_tr_b16 v[40:41], v53 offset:0
    ds_read_b64_tr_b16 v[42:43], v53 offset:896
    ds_read_b64_tr_b16 v[44:45], v53 offset:32
    ds_read_b64_tr_b16 v[46:47], v53 offset:928
    v_mfma_f32_32x32x16_bf16 v[64:79], v[32:35], v[16:19], v[64:79]
    s_add_u32 m0, s67, s88
    s_nop 0
    buffer_load_dwordx4 v13, s[32:35], s61 offen lds
    v_mfma_f32_32x32x16_bf16 v[80:95], v[32:35], v[20:23], v[80:95]
    s_add_u32 m0, s68, s88
    s_nop 0
    buffer_load_dwordx4 v14, s[36:39], s61 offen lds
    v_mfma_f32_32x32x16_bf16 v[96:111], v[36:39], v[16:19], v[96:111]
    s_add_u32 m0, s69, s88
    s_nop 0
    buffer_load_dwordx4 v15, s[36:39], s61 offen lds
    v_mfma_f32_32x32x16_bf16 v[112:127], v[36:39], v[20:23], v[112:127]
    s_waitcnt lgkmcnt(0)
    ds_read_b128 v[16:19], v50 offset:0
    ds_read_b128 v[20:23], v50 offset:4096
    ds_read_b64_tr_b16 v[32:33], v54 offset:0
    ds_read_b64_tr_b16 v[34:35], v54 offset:896
    ds_read_b64_tr_b16 v[36:37], v54 offset:32
    ds_read_b64_tr_b16 v[38:39], v54 offset:928
    v_mfma_f32_32x32x16_bf16 v[64:79], v[40:43], v[24:27], v[64:79]
    v_mfma_f32_32x32x16_bf16 v[80:95], v[40:43], v[28:31], v[80:95]
    v_mfma_f32_32x32x16_bf16 v[96:111], v[44:47], v[24:27], v[96:111]
    v_mfma_f32_32x32x16_bf16 v[112:127], v[44:47], v[28:31], v[112:127]
    s_waitcnt lgkmcnt(0)
    ds_read_b128 v[24:27], v51 offset:0
    ds_read_b128 v[28:31], v51 offset:4096
    ds_read_b64_tr_b16 v[40:41], v55 offset:0
    ds_read_b64_tr_b16 v[42:43], v55 offset:896
    ds_read_b64_tr_b16 v[44:45], v55 offset:32
    ds_read_b64_tr_b16 v[46:47], v55 offset:928
    v_mfma_f32_32x32x16_bf16 v[64:79], v[32:35], v[16:19], v[64:79]
    v_mfma_f32_32x32x16_bf16 v[80:95], v[32:35], v[20:23], v[80:95]
    v_mfma_f32_32x32x16_bf16 v[96:111], v[36:39], v[16:19], v[96:111]
    v_mfma_f32_32x32x16_bf16 v[112:127], v[36:39], v[20:23], v[112:127]
    s_waitcnt lgkmcnt(0)
    s_waitcnt vmcnt(6)
    s_barrier
    ds_read_b128 v[16:19], v48 offset:16384
    ds_read_b128 v[20:23], v48 offset:20480
    ds_read_b64_tr_b16 v[32:33], v52 offset:28928
    ds_read_b64_tr_b16 v[34:35], v52 offset:29824
    ds_read_b64_tr_b16 v[36:37], v52 offset:28960
    ds_read_b64_tr_b16 v[38:39], v52 offset:29856
    v_mfma_f32_32x32x16_bf16 v[64:79], v[40:43], v[24:27], v[64:79]
    s_add_u32 s63, s91, 6
    s_and_b32 s63, s63, 7
    s_lshl_b32 s60, s63, 7
    s_mul_i32 s61, s89, s63
    s_add_u32 m0, s64, 0
    s_nop 0
    buffer_load_dwordx4 v4, s[28:31], s60 offen lds
    v_mfma_f32_32x32x16_bf16 v[80:95], v[40:43], v[28:31], v[80:95]
    s_add_u32 m0, s65, 0
    s_nop 0
    buffer_load_dwordx4 v5, s[28:31], s60 offen lds
    v_mfma_f32_32x32x16_bf16 v[96:111], v[44:47], v[24:27], v[96:111]
    s_add_u32 m0, s66, 0
    s_nop 0
    buffer_load_dwordx4 v12, s[32:35], s61 offen lds
    v_mfma_f32_32x32x16_bf16 v[112:127], v[44:47], v[28:31], v[112:127]
    s_waitcnt lgkmcnt(0)
    ds_read_b128 v[24:27], v49 offset:16384
    ds_read_b128 v[28:31], v49 offset:20480
    ds_read_b64_tr_b16 v[40:41], v53 offset:28928
    ds_read_b64_tr_b16 v[42:43], v53 offset:29824
    ds_read_b64_tr_b16 v[44:45], v53 offset:28960
    ds_read_b64_tr_b16 v[46:47], v53 offset:29856
    v_mfma_f32_32x32x16_bf16 v[64:79], v[32:35], v[16:19], v[64:79]
    s_add_u32 m0, s67, 0
    s_nop 0
    buffer_load_dwordx4 v13, s[32:35], s61 offen lds
    v_mfma_f32_32x32x16_bf16 v[80:95], v[32:35], v[20:23], v[80:95]
    s_add_u32 m0, s68, 0
    s_nop 0
    buffer_load_dwordx4 v14, s[36:39], s61 offen lds
    v_mfma_f32_32x32x16_bf16 v[96:111], v[36:39], v[16:19], v[96:111]
    s_add_u32 m0, s69, 0
    s_nop 0
    buffer_load_dwordx4 v15, s[36:39], s61 offen lds
    v_mfma_f32_32x32x16_bf16 v[112:127], v[36:39], v[20:23], v[112:127]
    s_waitcnt lgkmcnt(0)
    ds_read_b128 v[16:19], v50 offset:16384
    ds_read_b128 v[20:23], v50 offset:20480
    ds_read_b64_tr_b16 v[32:33], v54 offset:28928
    ds_read_b64_tr_b16 v[34:35], v54 offset:29824
    ds_read_b64_tr_b16 v[36:37], v54 offset:28960
    ds_read_b64_tr_b16 v[38:39], v54 offset:29856
    v_mfma_f32_32x32x16_bf16 v[64:79], v[40:43], v[24:27], v[64:79]
    v_mfma_f32_32x32x16_bf16 v[80:95], v[40:43], v[28:31], v[80:95]
    v_mfma_f32_32x32x16_bf16 v[96:111], v[44:47], v[24:27], v[96:111]
    v_mfma_f32_32x32x16_bf16 v[112:127], v[44:47], v[28:31], v[112:127]
    s_waitcnt lgkmcnt(0)
    ds_read_b128 v[24:27], v51 offset:16384
    ds_read_b128 v[28:31], v51 offset:20480
    ds_read_b64_tr_b16 v[40:41], v55 offset:28928
    ds_read_b64_tr_b16 v[42:43], v55 offset:29824
    ds_read_b64_tr_b16 v[44:45], v55 offset:28960
    ds_read_b64_tr_b16 v[46:47], v55 offset:29856
    v_mfma_f32_32x32x16_bf16 v[64:79], v[32:35], v[16:19], v[64:79]
    v_mfma_f32_32x32x16_bf16 v[80:95], v[32:35], v[20:23], v[80:95]
    v_mfma_f32_32x32x16_bf16 v[96:111], v[36:39], v[16:19], v[96:111]
    v_mfma_f32_32x32x16_bf16 v[112:127], v[36:39], v[20:23], v[112:127]
    s_waitcnt lgkmcnt(0)
    s_waitcnt vmcnt(6)
    s_barrier
    ds_read_b128 v[16:19], v48 offset:32768
    ds_read_b128 v[20:23], v48 offset:36864
    ds_read_b64_tr_b16 v[32:33], v52 offset:57856
    ds_read_b64_tr_b16 v[34:35], v52 offset:58752
    ds_read_b64_tr_b16 v[36:37], v52 offset:57888
    ds_read_b64_tr_b16 v[38:39], v52 offset:58784
    v_mfma_f32_32x32x16_bf16 v[64:79], v[40:43], v[24:27], v[64:79]
    s_add_u32 s63, s91, 7
    s_and_b32 s63, s63, 7
    s_lshl_b32 s60, s63, 7
    s_mul_i32 s61, s89, s63
    s_add_u32 m0, s64, 16384
    s_nop 0
    buffer_load_dwordx4 v4, s[28:31], s60 offen lds
    v_mfma_f32_32x32x16_bf16 v[80:95], v[40:43], v[28:31], v[80:95]
    s_add_u32 m0, s65, 16384
    s_nop 0
    buffer_load_dwordx4 v5, s[28:31], s60 offen lds
    v_mfma_f32_32x32x16_bf16 v[96:111], v[44:47], v[24:27], v[96:111]
    s_add_u32 m0, s66, s87
    s_nop 0
    buffer_load_dwordx4 v12, s[32:35], s61 offen lds
    v_mfma_f32_32x32x16_bf16 v[112:127], v[44:47], v[28:31], v[112:127]
    s_waitcnt lgkmcnt(0)
    ds_read_b128 v[24:27], v49 offset:32768
    ds_read_b128 v[28:31], v49 offset:36864
    ds_read_b64_tr_b16 v[40:41], v53 offset:57856
    ds_read_b64_tr_b16 v[42:43], v53 offset:58752
    ds_read_b64_tr_b16 v[44:45], v53 offset:57888
    ds_read_b64_tr_b16 v[46:47], v53 offset:58784
    v_mfma_f32_32x32x16_bf16 v[64:79], v[32:35], v[16:19], v[64:79]
    s_add_u32 m0, s67, s87
    s_nop 0
    buffer_load_dwordx4 v13, s[32:35], s61 offen lds
    v_mfma_f32_32x32x16_bf16 v[80:95], v[32:35], v[20:23], v[80:95]
    s_add_u32 m0, s68, s87
    s_nop 0
    buffer_load_dwordx4 v14, s[36:39], s61 offen lds
    v_mfma_f32_32x32x16_bf16 v[96:111], v[36:39], v[16:19], v[96:111]
    s_add_u32 m0, s69, s87
    s_nop 0
    buffer_load_dwordx4 v15, s[36:39], s61 offen lds
    v_mfma_f32_32x32x16_bf16 v[112:127], v[36:39], v[20:23], v[112:127]
    s_waitcnt lgkmcnt(0)
    ds_read_b128 v[16:19], v50 offset:32768
    ds_read_b128 v[20:23], v50 offset:36864
    ds_read_b64_tr_b16 v[32:33], v54 offset:57856
    ds_read_b64_tr_b16 v[34:35], v54 offset:58752
    ds_read_b64_tr_b16 v[36:37], v54 offset:57888
    ds_read_b64_tr_b16 v[38:39], v54 offset:58784
    v_mfma_f32_32x32x16_bf16 v[64:79], v[40:43], v[24:27], v[64:79]
    v_mfma_f32_32x32x16_bf16 v[80:95], v[40:43], v[28:31], v[80:95]
    v_mfma_f32_32x32x16_bf16 v[96:111], v[44:47], v[24:27], v[96:111]
    v_mfma_f32_32x32x16_bf16 v[112:127], v[44:47], v[28:31], v[112:127]
    s_waitcnt lgkmcnt(0)
    ds_read_b128 v[24:27], v51 offset:32768
    ds_read_b128 v[28:31], v51 offset:36864
    ds_read_b64_tr_b16 v[40:41], v55 offset:57856
    ds_read_b64_tr_b16 v[42:43], v55 offset:58752
    ds_read_b64_tr_b16 v[44:45], v55 offset:57888
    ds_read_b64_tr_b16 v[46:47], v55 offset:58784
    v_mfma_f32_32x32x16_bf16 v[64:79], v[32:35], v[16:19], v[64:79]
    v_mfma_f32_32x32x16_bf16 v[80:95], v[32:35], v[20:23], v[80:95]
    v_mfma_f32_32x32x16_bf16 v[96:111], v[36:39], v[16:19], v[96:111]
    v_mfma_f32_32x32x16_bf16 v[112:127], v[36:39], v[20:23], v[112:127]
    s_waitcnt lgkmcnt(0)
    s_waitcnt vmcnt(6)
    s_barrier
    ds_read_b128 v[16:19], v48 offset:0
    ds_read_b128 v[20:23], v48 offset:4096
    ds_read_b64_tr_b16 v[32:33], v52 offset:0
    ds_read_b64_tr_b16 v[34:35], v52 offset:896
    ds_read_b64_tr_b16 v[36:37], v52 offset:32
    ds_read_b64_tr_b16 v[38:39], v52 offset:928
    v_mfma_f32_32x32x16_bf16 v[64:79], v[40:43], v[24:27], v[64:79]
    v_mfma_f32_32x32x16_bf16 v[80:95], v[40:43], v[28:31], v[80:95]
    v_mfma_f32_32x32x16_bf16 v[96:111], v[44:47], v[24:27], v[96:111]
    v_mfma_f32_32x32x16_bf16 v[112:127], v[44:47], v[28:31], v[112:127]
    s_waitcnt lgkmcnt(0)
    ds_read_b128 v[24:27], v49 offset:0
    ds_read_b128 v[28:31], v49 offset:4096
    ds_read_b64_tr_b16 v[40:41], v53 offset:0
    ds_read_b64_tr_b16 v[42:43], v53 offset:896
    ds_read_b64_tr_b16 v[44:45], v53 offset:32
    ds_read_b64_tr_b16 v[46:47], v53 offset:928
    v_mfma_f32_32x32x16_bf16 v[64:79], v[32:35], v[16:19], v[64:79]
    v_mfma_f32_32x32x16_bf16 v[80:95], v[32:35], v[20:23], v[80:95]
    v_mfma_f32_32x32x16_bf16 v[96:111], v[36:39], v[16:19], v[96:111]
    v_mfma_f32_32x32x16_bf16 v[112:127], v[36:39], v[20:23], v[112:127]
    s_waitcnt lgkmcnt(0)
    ds_read_b128 v[16:19], v50 offset:0
    ds_read_b128 v[20:23], v50 offset:4096
    ds_read_b64_tr_b16 v[32:33], v54 offset:0
    ds_read_b64_tr_b16 v[34:35], v54 offset:896
    ds_read_b64_tr_b16 v[36:37], v54 offset:32
    ds_read_b64_tr_b16 v[38:39], v54 offset:928
    v_mfma_f32_32x32x16_bf16 v[64:79], v[40:43], v[24:27], v[64:79]
    v_mfma_f32_32x32x16_bf16 v[80:95], v[40:43], v[28:31], v[80:95]
    v_mfma_f32_32x32x16_bf16 v[96:111], v[44:47], v[24:27], v[96:111]
    v_mfma_f32_32x32x16_bf16 v[112:127], v[44:47], v[28:31], v[112:127]
    s_waitcnt lgkmcnt(0)
    ds_read_b128 v[24:27], v51 offset:0
    ds_read_b128 v[28:31], v51 offset:4096
    ds_read_b64_tr_b16 v[40:41], v55 offset:0
    ds_read_b64_tr_b16 v[42:43], v55 offset:896
    ds_read_b64_tr_b16 v[44:45], v55 offset:32
    ds_read_b64_tr_b16 v[46:47], v55 offset:928
    v_mfma_f32_32x32x16_bf16 v[64:79], v[32:35], v[16:19], v[64:79]
    v_mfma_f32_32x32x16_bf16 v[80:95], v[32:35], v[20:23], v[80:95]
    v_mfma_f32_32x32x16_bf16 v[96:111], v[36:39], v[16:19], v[96:111]
    v_mfma_f32_32x32x16_bf16 v[112:127], v[36:39], v[20:23], v[112:127]
    s_waitcnt lgkmcnt(0)
    s_waitcnt vmcnt(0)
    s_barrier
    ds_read_b128 v[16:19], v48 offset:16384
    ds_read_b128 v[20:23], v48 offset:20480
    ds_read_b64_tr_b16 v[32:33], v52 offset:28928
    ds_read_b64_tr_b16 v[34:35], v52 offset:29824
    ds_read_b64_tr_b16 v[36:37], v52 offset:28960
    ds_read_b64_tr_b16 v[38:39], v52 offset:29856
    v_mfma_f32_32x32x16_bf16 v[64:79], v[40:43], v[24:27], v[64:79]
    v_mfma_f32_32x32x16_bf16 v[80:95], v[40:43], v[28:31], v[80:95]
    v_mfma_f32_32x32x16_bf16 v[96:111], v[44:47], v[24:27], v[96:111]
    v_mfma_f32_32x32x16_bf16 v[112:127], v[44:47], v[28:31], v[112:127]
    s_waitcnt lgkmcnt(0)
    ds_read_b128 v[24:27], v49 offset:16384
    ds_read_b128 v[28:31], v49 offset:20480
    ds_read_b64_tr_b16 v[40:41], v53 offset:28928
    ds_read_b64_tr_b16 v[42:43], v53 offset:29824
    ds_read_b64_tr_b16 v[44:45], v53 offset:28960
    ds_read_b64_tr_b16 v[46:47], v53 offset:29856
    ds_read_b64 v[148:149], v61 offset:0
    ds_read_b64 v[152:153], v61 offset:8
    ds_read2_b32 v[156:157], v62 offset0:0 offset1:0
    ds_read2_b32 v[160:161], v62 offset0:64 offset1:64
    v_mfma_f32_32x32x16_bf16 v[64:79], v[32:35], v[16:19], v[64:79]
    v_mfma_f32_32x32x16_bf16 v[80:95], v[32:35], v[20:23], v[80:95]
    v_mfma_f32_32x32x16_bf16 v[96:111], v[36:39], v[16:19], v[96:111]
    v_mfma_f32_32x32x16_bf16 v[112:127], v[36:39], v[20:23], v[112:127]
    s_waitcnt lgkmcnt(0)
    ds_read_b128 v[16:19], v50 offset:16384
    ds_read_b128 v[20:23], v50 offset:20480
    ds_read_b64_tr_b16 v[32:33], v54 offset:28928
    ds_read_b64_tr_b16 v[34:35], v54 offset:29824
    ds_read_b64_tr_b16 v[36:37], v54 offset:28960
    ds_read_b64_tr_b16 v[38:39], v54 offset:29856
    v_mfma_f32_32x32x16_bf16 v[64:79], v[40:43], v[24:27], v[64:79]
    v_mfma_f32_32x32x16_bf16 v[80:95], v[40:43], v[28:31], v[80:95]
    v_mfma_f32_32x32x16_bf16 v[96:111], v[44:47], v[24:27], v[96:111]
    v_mfma_f32_32x32x16_bf16 v[112:127], v[44:47], v[28:31], v[112:127]
    v_mfma_f32_32x32x16_bf16 v[64:79], v[148:151], v[156:159], v[64:79]
    v_mfma_f32_32x32x16_bf16 v[80:95], v[148:151], v[160:163], v[80:95]
    v_mfma_f32_32x32x16_bf16 v[96:111], v[152:155], v[156:159], v[96:111]
    v_mfma_f32_32x32x16_bf16 v[112:127], v[152:155], v[160:163], v[112:127]
    s_waitcnt lgkmcnt(0)
    ds_read_b128 v[24:27], v51 offset:16384
    ds_read_b128 v[28:31], v51 offset:20480
    ds_read_b64_tr_b16 v[40:41], v55 offset:28928
    ds_read_b64_tr_b16 v[42:43], v55 offset:29824
    ds_read_b64_tr_b16 v[44:45], v55 offset:28960
    ds_read_b64_tr_b16 v[46:47], v55 offset:29856
    v_mfma_f32_32x32x16_bf16 v[64:79], v[32:35], v[16:19], v[64:79]
    v_mfma_f32_32x32x16_bf16 v[80:95], v[32:35], v[20:23], v[80:95]
    v_mfma_f32_32x32x16_bf16 v[96:111], v[36:39], v[16:19], v[96:111]
    v_mfma_f32_32x32x16_bf16 v[112:127], v[36:39], v[20:23], v[112:127]
    s_lshl_b32 s59, s57, 2
    s_lshl_b32 s60, s70, 1
    s_add_u32 s59, s59, s60
    s_mul_i32 s60, s59, 112
    s_mul_i32 s61, s58, 7
    s_add_u32 s60, s60, s61
    s_lshl_b32 s61, s71, 1
    s_add_u32 s60, s60, s61
    s_lshl_b32 s60, s60, 10
    s_add_u32 s60, s60, 8912896
    s_waitcnt lgkmcnt(0)
    v_mfma_f32_32x32x16_bf16 v[64:79], v[40:43], v[24:27], v[64:79]
    v_mfma_f32_32x32x16_bf16 v[80:95], v[40:43], v[28:31], v[80:95]
    v_mfma_f32_32x32x16_bf16 v[96:111], v[44:47], v[24:27], v[96:111]
    v_mfma_f32_32x32x16_bf16 v[112:127], v[44:47], v[28:31], v[112:127]
    s_cmp_lt_u32 s56, 4
    s_cbranch_scc1 .Lnobe
    s_setprio 2
    s_barrier
.Lnobe:
    s_nop 8
    v_max_f32 v64, 0, v64
    v_max_f32 v65, 0, v65
    v_max_f32 v66, 0, v66
    v_max_f32 v67, 0, v67
    v_max_f32 v68, 0, v68
    v_max_f32 v69, 0, v69
    v_max_f32 v70, 0, v70
    v_max_f32 v71, 0, v71
    v_mul_f32 v64, v64, v72
    v_mul_f32 v65, v65, v73
    v_cvt_pk_bf16_f32 v52, v64, v65
    v_mul_f32 v66, v66, v74
    v_mul_f32 v67, v67, v75
    v_cvt_pk_bf16_f32 v53, v66, v67
    v_mul_f32 v68, v68, v76
    v_mul_f32 v69, v69, v77
    v_cvt_pk_bf16_f32 v54, v68, v69
    v_mul_f32 v70, v70, v78
    v_mul_f32 v71, v71, v79
    v_cvt_pk_bf16_f32 v55, v70, v71
    s_add_u32 s62, s60, 0
    buffer_store_dwordx4 v[52:55], v144, s[40:43], s62 offen offset:0 sc1
    v_max_f32 v80, 0, v80
    v_max_f32 v81, 0, v81
    v_max_f32 v82, 0, v82
    v_max_f32 v83, 0, v83
    v_max_f32 v84, 0, v84
    v_max_f32 v85, 0, v85
    v_max_f32 v86, 0, v86
    v_max_f32 v87, 0, v87
    v_mul_f32 v80, v80, v88
    v_mul_f32 v81, v81, v89
    v_cvt_pk_bf16_f32 v56, v80, v81
    v_mul_f32 v82, v82, v90
    v_mul_f32 v83, v83, v91
    v_cvt_pk_bf16_f32 v57, v82, v83
    v_mul_f32 v84, v84, v92
    v_mul_f32 v85, v85, v93
    v_cvt_pk_bf16_f32 v58, v84, v85
    v_mul_f32 v86, v86, v94
    v_mul_f32 v87, v87, v95
    v_cvt_pk_bf16_f32 v59, v86, v87
    s_add_u32 s62, s60, 114688
    buffer_store_dwordx4 v[56:59], v144, s[40:43], s62 offen offset:0 sc1
    v_max_f32 v96, 0, v96
    v_max_f32 v97, 0, v97
    v_max_f32 v98, 0, v98
    v_max_f32 v99, 0, v99
    v_max_f32 v100, 0, v100
    v_max_f32 v101, 0, v101
    v_max_f32 v102, 0, v102
    v_max_f32 v103, 0, v103
    v_mul_f32 v96, v96, v104
    v_mul_f32 v97, v97, v105
    v_cvt_pk_bf16_f32 v60, v96, v97
    v_mul_f32 v98, v98, v106
    v_mul_f32 v99, v99, v107
    v_cvt_pk_bf16_f32 v61, v98, v99
    v_mul_f32 v100, v100, v108
    v_mul_f32 v101, v101, v109
    v_cvt_pk_bf16_f32 v62, v100, v101
    v_mul_f32 v102, v102, v110
    v_mul_f32 v103, v103, v111
    v_cvt_pk_bf16_f32 v63, v102, v103
    s_add_u32 s62, s60, 0
    buffer_store_dwordx4 v[60:63], v144, s[40:43], s62 offen offset:1024 sc1
    v_max_f32 v112, 0, v112
    v_max_f32 v113, 0, v113
    v_max_f32 v114, 0, v114
    v_max_f32 v115, 0, v115
    v_max_f32 v116, 0, v116
    v_max_f32 v117, 0, v117
    v_max_f32 v118, 0, v118
    v_max_f32 v119, 0, v119
    v_mul_f32 v112, v112, v120
    v_mul_f32 v113, v113, v121
    v_cvt_pk_bf16_f32 v48, v112, v113
    v_mul_f32 v114, v114, v122
    v_mul_f32 v115, v115, v123
    v_cvt_pk_bf16_f32 v49, v114, v115
    v_mul_f32 v116, v116, v124
    v_mul_f32 v117, v117, v125
    v_cvt_pk_bf16_f32 v50, v116, v117
    v_mul_f32 v118, v118, v126
    v_mul_f32 v119, v119, v127
    v_cvt_pk_bf16_f32 v51, v118, v119
    s_add_u32 s62, s60, 114688
    buffer_store_dwordx4 v[48:51], v144, s[40:43], s62 offen offset:1024 sc1
    s_branch .Lattn
.LvarB:
    s_mov_b32 s91, s57
    s_add_u32 s63, s91, 0
    s_and_b32 s63, s63, 7
    s_lshl_b32 s60, s63, 7
    s_mul_i32 s61, s89, s63
    s_add_u32 m0, s64, 0
    s_nop 0
    buffer_load_dwordx4 v4, s[28:31], s60 offen lds
    s_add_u32 m0, s65, 0
    s_nop 0
    buffer_load_dwordx4 v5, s[28:31], s60 offen lds
    s_add_u32 m0, s66, 0
    s_nop 0
    buffer_load_dwordx4 v12, s[32:35], s61 offen lds
    s_add_u32 m0, s67, 0
    s_nop 0
    buffer_load_dwordx4 v13, s[32:35], s61 offen lds
    s_add_u32 m0, s68, 0
    s_nop 0
    buffer_load_dwordx4 v14, s[36:39], s61 offen lds
    s_add_u32 m0, s69, 0
    s_nop 0
    buffer_load_dwordx4 v15, s[36:39], s61 offen lds
    s_add_u32 s92, s26, 2031616
    s_addc_u32 s93, s27, 0
    s_load_dword s90, s[92:93], 0
    s_and_b32 s70, s56, 1
    s_lshr_b32 s71, s56, 1
    s_add_u32 s71, s71, 3
    s_and_b32 s71, s71, 3
    s_lshr_b32 s72, s57, 3
    s_lshl_b32 s72, s72, 1
    s_add_u32 s72, s72, s70
    v_and_b32 v2, 31, v1
    v_lshrrev_b32 v3, 5, v1
    v_lshrrev_b32 v6, 1, v2
    v_and_b32 v6, 7, v6
    v_xor_b32 v6, v6, v3
    s_lshl_b32 s59, s70, 13
    v_lshlrev_b32 v7, 7, v2
    v_add_u32 v7, s59, v7
    v_lshl_add_u32 v7, v6, 4, v7
    s_xor_b32 s59, s72, 0
    s_lshl_b32 s59, s59, 5
    v_xor_b32 v48, s59, v7
    s_xor_b32 s59, s72, 1
    s_lshl_b32 s59, s59, 5
    v_xor_b32 v49, s59, v7
    s_xor_b32 s59, s72, 2
    s_lshl_b32 s59, s59, 5
    v_xor_b32 v50, s59, v7
    s_xor_b32 s59, s72, 3
    s_lshl_b32 s59, s59, 5
    v_xor_b32 v51, s59, v7
    s_barrier
    s_add_u32 s63, s91, 1
    s_and_b32 s63, s63, 7
    s_lshl_b32 s60, s63, 7
    s_mul_i32 s61, s89, s63
    s_add_u32 m0, s64, 16384
    s_nop 0
    buffer_load_dwordx4 v4, s[28:31], s60 offen lds
    v_and_b32 v6, 1, v1
    v_lshlrev_b32 v6, 1, v6
    v_bfe_u32 v7, v1, 1, 1
    v_or_b32 v6, v6, v7
    v_bfe_u32 v7, v1, 2, 2
    v_lshl_add_u32 v7, v3, 3, v7
    v_bfe_u32 v8, v1, 4, 1
    s_add_u32 m0, s65, 16384
    s_nop 0
    buffer_load_dwordx4 v5, s[28:31], s60 offen lds
    v_mul_u32_u24 v9, 224, v7
    v_lshl_add_u32 v9, v6, 3, v9
    v_mul_u32_u24 v11, 14464, v8
    v_add_u32 v9, v9, v11
    s_lshl_b32 s59, s71, 6
    s_add_u32 s59, s59, 49152
    v_add_u32 v9, s59, v9
    s_add_u32 m0, s66, s87
    s_nop 0
    buffer_load_dwordx4 v12, s[32:35], s61 offen lds
    s_xor_b32 s59, s72, 0
    s_mul_i32 s62, s59, 3584
    v_add_u32 v52, s62, v9
    s_xor_b32 s59, s72, 1
    s_mul_i32 s62, s59, 3584
    v_add_u32 v53, s62, v9
    s_xor_b32 s59, s72, 2
    s_mul_i32 s62, s59, 3584
    v_add_u32 v54, s62, v9
    s_xor_b32 s59, s72, 3
    s_mul_i32 s62, s59, 3584
    v_add_u32 v55, s62, v9
    s_add_u32 m0, s67, s87
    s_nop 0
    buffer_load_dwordx4 v13, s[32:35], s61 offen lds
    v_lshlrev_b32 v11, 6, v7
    v_lshl_add_u32 v11, v6, 3, v11
    v_lshl_add_u32 v11, v8, 5, v11
    v_add_u32 v11, 135936, v11
    s_xor_b32 s59, s72, 0
    s_lshl_b32 s62, s59, 10
    v_add_u32 v56, s62, v11
    s_xor_b32 s59, s72, 1
    s_lshl_b32 s62, s59, 10
    v_add_u32 v57, s62, v11
    s_xor_b32 s59, s72, 2
    s_lshl_b32 s62, s59, 10
    v_add_u32 v58, s62, v11
    s_xor_b32 s59, s72, 3
    s_lshl_b32 s62, s59, 10
    v_add_u32 v59, s62, v11
    v_and_b32 v7, 15, v1
    v_lshlrev_b32 v8, 2, v8
    v_cmp_eq_u32 vcc, v7, v8
    v_mov_b32 v9, 0x3f803f80
    s_nop 0
    v_cndmask_b32 v136, 0, v9, vcc
    v_cndmask_b32 v137, 0, v9, vcc
    v_cndmask_b32 v138, 0, v9, vcc
    v_cndmask_b32 v139, 0, v9, vcc
    s_lshl_b32 s59, s56, 8
    s_add_u32 s59, s59, 148480
    v_lshl_add_u32 v60, v2, 3, s59
    s_lshr_b32 s59, s56, 1
    s_lshl_b32 s59, s59, 9
    s_add_u32 s59, s59, 148480
    v_lshl_add_u32 v61, v2, 4, s59
    v_mov_b32 v7, 160384
    v_cmp_gt_u32 vcc, 32, v1
    s_lshl_b32 s59, s70, 9
    s_add_u32 s59, s59, 150528
    v_cndmask_b32 v61, v7, v61, vcc
    v_lshl_add_u32 v62, v2, 3, s59
    v_mov_b32 v150, 0
    v_mov_b32 v151, 0
    v_mov_b32 v154, 0
    v_mov_b32 v155, 0
    v_mov_b32 v158, 0
    v_mov_b32 v159, 0
    v_mov_b32 v162, 0
    v_mov_b32 v163, 0
    s_waitcnt lgkmcnt(0)
    s_mul_i32 s90, s90, 0x9e3779b1
    s_add_u32 s90, s90, 0x7f4a7c15
    s_waitcnt vmcnt(4)
    s_barrier
    ds_read_b128 v[16:19], v48 offset:0
    ds_read_b128 v[20:23], v48 offset:4096
    ds_read_b64_tr_b16 v[32:33], v52 offset:0
    ds_read_b64_tr_b16 v[34:35], v52 offset:896
    ds_read_b64_tr_b16 v[36:37], v56 offset:0
    ds_read_b64_tr_b16 v[38:39], v56 offset:256
    s_waitcnt lgkmcnt(0)
    ds_read_b128 v[24:27], v49 offset:0
    ds_read_b128 v[28:31], v49 offset:4096
    ds_read_b64_tr_b16 v[40:41], v53 offset:0
    ds_read_b64_tr_b16 v[42:43], v53 offset:896
    ds_read_b64_tr_b16 v[44:45], v57 offset:0
    ds_read_b64_tr_b16 v[46:47], v57 offset:256
    v_mfma_f32_32x32x16_bf16 v[96:111], v[36:39], v[16:19], 0
    s_add_u32 m0, s68, s87
    s_nop 0
    buffer_load_dwordx4 v14, s[36:39], s61 offen lds
    v_mfma_f32_32x32x16_bf16 v[112:127], v[36:39], v[20:23], 0
    s_add_u32 m0, s69, s87
    s_nop 0
    buffer_load_dwordx4 v15, s[36:39], s61 offen lds
    v_mfma_f32_32x32x16_bf16 v[64:79], v[32:35], v[16:19], 0
    s_add_u32 s63, s91, 2
    s_and_b32 s63, s63, 7
    s_lshl_b32 s60, s63, 7
    s_mul_i32 s61, s89, s63
    s_add_u32 m0, s64, 32768
    s_nop 0
    buffer_load_dwordx4 v4, s[28:31], s60 offen lds
    v_mfma_f32_32x32x16_bf16 v[80:95], v[32:35], v[20:23], 0
    v_mfma_f32_16x16x32_bf16 v[128:131], v[136:139], v[32:35], 0
    v_mfma_f32_16x16x32_bf16 v[132:135], v[136:139], v[36:39], 0
    s_waitcnt lgkmcnt(0)
    ds_read_b128 v[16:19], v50 offset:0
    ds_read_b128 v[20:23], v50 offset:4096
    ds_read_b64_tr_b16 v[32:33], v54 offset:0
    ds_read_b64_tr_b16 v[34:35], v54 offset:896
    ds_read_b64_tr_b16 v[36:37], v58 offset:0
    ds_read_b64_tr_b16 v[38:39], v58 offset:256
    v_mfma_f32_32x32x16_bf16 v[96:111], v[44:47], v[24:27], v[96:111]
    s_add_u32 m0, s65, 32768
    s_nop 0
    buffer_load_dwordx4 v5, s[28:31], s60 offen lds
    v_mfma_f32_32x32x16_bf16 v[112:127], v[44:47], v[28:31], v[112:127]
    s_add_u32 m0, s66, s88
    s_nop 0
    buffer_load_dwordx4 v12, s[32:35], s61 offen lds
    v_mfma_f32_32x32x16_bf16 v[64:79], v[40:43], v[24:27], v[64:79]
    s_add_u32 m0, s67, s88
    s_nop 0
    buffer_load_dwordx4 v13, s[32:35], s61 offen lds
    v_mfma_f32_32x32x16_bf16 v[80:95], v[40:43], v[28:31], v[80:95]
    v_mov_b32 v129, v132
    s_mov_b64 exec, 0xffffffff
    ds_write_b64 v60, v[128:129]
    s_mov_b64 exec, -1
    s_waitcnt lgkmcnt(0)
    ds_read_b128 v[24:27], v51 offset:0
    ds_read_b128 v[28:31], v51 offset:4096
    ds_read_b64_tr_b16 v[40:41], v55 offset:0
    ds_read_b64_tr_b16 v[42:43], v55 offset:896
    ds_read_b64_tr_b16 v[44:45], v59 offset:0
    ds_read_b64_tr_b16 v[46:47], v59 offset:256
    v_mfma_f32_32x32x16_bf16 v[96:111], v[36:39], v[16:19], v[96:111]
    s_add_u32 m0, s68, s88
    s_nop 0
    buffer_load_dwordx4 v14, s[36:39], s61 offen lds
    v_mfma_f32_32x32x16_bf16 v[112:127], v[36:39], v[20:23], v[112:127]
    s_add_u32 m0, s69, s88
    s_nop 0
    buffer_load_dwordx4 v15, s[36:39], s61 offen lds
    v_mfma_f32_32x32x16_bf16 v[64:79], v[32:35], v[16:19], v[64:79]
    v_mfma_f32_32x32x16_bf16 v[80:95], v[32:35], v[20:23], v[80:95]
    s_waitcnt lgkmcnt(0)
    s_waitcnt vmcnt(6)
    s_barrier
    ds_read_b128 v[16:19], v48 offset:16384
    ds_read_b128 v[20:23], v48 offset:20480
    ds_read_b64_tr_b16 v[32:33], v52 offset:28928
    ds_read_b64_tr_b16 v[34:35], v52 offset:29824
    ds_read_b64_tr_b16 v[36:37], v56 offset:4096
    ds_read_b64_tr_b16 v[38:39], v56 offset:4352
    v_mfma_f32_32x32x16_bf16 v[96:111], v[44:47], v[24:27], v[96:111]
    s_add_u32 s63, s91, 3
    s_and_b32 s63, s63, 7
    s_lshl_b32 s60, s63, 7
    s_mul_i32 s61, s89, s63
    s_add_u32 m0, s64, 0
    s_nop 0
    buffer_load_dwordx4 v4, s[28:31], s60 offen lds
    v_mfma_f32_32x32x16_bf16 v[112:127], v[44:47], v[28:31], v[112:127]
    s_add_u32 m0, s65, 0
    s_nop 0
    buffer_load_dwordx4 v5, s[28:31], s60 offen lds
    v_mfma_f32_32x32x16_bf16 v[64:79], v[40:43], v[24:27], v[64:79]
    s_add_u32 m0, s66, 0
    s_nop 0
    buffer_load_dwordx4 v12, s[32:35], s61 offen lds
    v_mfma_f32_32x32x16_bf16 v[80:95], v[40:43], v[28:31], v[80:95]
    s_waitcnt lgkmcnt(0)
    ds_read_b128 v[24:27], v49 offset:16384
    ds_read_b128 v[28:31], v49 offset:20480
    ds_read_b64_tr_b16 v[40:41], v53 offset:28928
    ds_read_b64_tr_b16 v[42:43], v53 offset:29824
    ds_read_b64_tr_b16 v[44:45], v57 offset:4096
    ds_read_b64_tr_b16 v[46:47], v57 offset:4352
    v_mfma_f32_32x32x16_bf16 v[96:111], v[36:39], v[16:19], v[96:111]
    s_add_u32 m0, s67, 0
    s_nop 0
    buffer_load_dwordx4 v13, s[32:35], s61 offen lds
    v_mfma_f32_32x32x16_bf16 v[112:127], v[36:39], v[20:23], v[112:127]
    s_add_u32 m0, s68, 0
    s_nop 0
    buffer_load_dwordx4 v14, s[36:39], s61 offen lds
    v_mfma_f32_32x32x16_bf16 v[64:79], v[32:35], v[16:19], v[64:79]
    s_add_u32 m0, s69, 0
    s_nop 0
    buffer_load_dwordx4 v15, s[36:39], s61 offen lds
    v_mfma_f32_32x32x16_bf16 v[80:95], v[32:35], v[20:23], v[80:95]
    s_waitcnt lgkmcnt(0)
    ds_read_b128 v[16:19], v50 offset:16384
    ds_read_b128 v[20:23], v50 offset:20480
    ds_read_b64_tr_b16 v[32:33], v54 offset:28928
    ds_read_b64_tr_b16 v[34:35], v54 offset:29824
    ds_read_b64_tr_b16 v[36:37], v58 offset:4096
    ds_read_b64_tr_b16 v[38:39], v58 offset:4352
    v_mfma_f32_32x32x16_bf16 v[96:111], v[44:47], v[24:27], v[96:111]
    v_mfma_f32_32x32x16_bf16 v[112:127], v[44:47], v[28:31], v[112:127]
    v_mfma_f32_32x32x16_bf16 v[64:79], v[40:43], v[24:27], v[64:79]
    v_mfma_f32_32x32x16_bf16 v[80:95], v[40:43], v[28:31], v[80:95]
    s_waitcnt lgkmcnt(0)
    ds_read_b128 v[24:27], v51 offset:16384
    ds_read_b128 v[28:31], v51 offset:20480
    ds_read_b64_tr_b16 v[40:41], v55 offset:28928
    ds_read_b64_tr_b16 v[42:43], v55 offset:29824
    ds_read_b64_tr_b16 v[44:45], v59 offset:4096
    ds_read_b64_tr_b16 v[46:47], v59 offset:4352
    v_mfma_f32_32x32x16_bf16 v[96:111], v[36:39], v[16:19], v[96:111]
    v_mfma_f32_32x32x16_bf16 v[112:127], v[36:39], v[20:23], v[112:127]
    v_mfma_f32_32x32x16_bf16 v[64:79], v[32:35], v[16:19], v[64:79]
    v_mfma_f32_32x32x16_bf16 v[80:95], v[32:35], v[20:23], v[80:95]
    s_waitcnt lgkmcnt(0)
    s_waitcnt vmcnt(6)
    s_barrier
    ds_read_b128 v[16:19], v48 offset:32768
    ds_read_b128 v[20:23], v48 offset:36864
    ds_read_b64_tr_b16 v[32:33], v52 offset:57856
    ds_read_b64_tr_b16 v[34:35], v52 offset:58752
    ds_read_b64_tr_b16 v[36:37], v56 offset:8192
    ds_read_b64_tr_b16 v[38:39], v56 offset:8448
    v_mfma_f32_32x32x16_bf16 v[96:111], v[44:47], v[24:27], v[96:111]
    s_add_u32 s63, s91, 4
    s_and_b32 s63, s63, 7
    s_lshl_b32 s60, s63, 7
    s_mul_i32 s61, s89, s63
    s_add_u32 m0, s64, 16384
    s_nop 0
    buffer_load_dwordx4 v4, s[28:31], s60 offen lds
    v_mfma_f32_32x32x16_bf16 v[112:127], v[44:47], v[28:31], v[112:127]
    s_add_u32 m0, s65, 16384
    s_nop 0
    buffer_load_dwordx4 v5, s[28:31], s60 offen lds
    v_mfma_f32_32x32x16_bf16 v[64:79], v[40:43], v[24:27], v[64:79]
    s_add_u32 m0, s66, s87
    s_nop 0
    buffer_load_dwordx4 v12, s[32:35], s61 offen lds
    v_mfma_f32_32x32x16_bf16 v[80:95], v[40:43], v[28:31], v[80:95]
    s_waitcnt lgkmcnt(0)
    ds_read_b128 v[24:27], v49 offset:32768
    ds_read_b128 v[28:31], v49 offset:36864
    ds_read_b64_tr_b16 v[40:41], v53 offset:57856
    ds_read_b64_tr_b16 v[42:43], v53 offset:58752
    ds_read_b64_tr_b16 v[44:45], v57 offset:8192
    ds_read_b64_tr_b16 v[46:47], v57 offset:8448
    v_mfma_f32_32x32x16_bf16 v[96:111], v[36:39], v[16:19], v[96:111]
    s_add_u32 m0, s67, s87
    s_nop 0
    buffer_load_dwordx4 v13, s[32:35], s61 offen lds
    v_mfma_f32_32x32x16_bf16 v[112:127], v[36:39], v[20:23], v[112:127]
    s_add_u32 m0, s68, s87
    s_nop 0
    buffer_load_dwordx4 v14, s[36:39], s61 offen lds
    v_mfma_f32_32x32x16_bf16 v[64:79], v[32:35], v[16:19], v[64:79]
    s_add_u32 m0, s69, s87
    s_nop 0
    buffer_load_dwordx4 v15, s[36:39], s61 offen lds
    v_mfma_f32_32x32x16_bf16 v[80:95], v[32:35], v[20:23], v[80:95]
    s_waitcnt lgkmcnt(0)
    ds_read_b128 v[16:19], v50 offset:32768
    ds_read_b128 v[20:23], v50 offset:36864
    ds_read_b64_tr_b16 v[32:33], v54 offset:57856
    ds_read_b64_tr_b16 v[34:35], v54 offset:58752
    ds_read_b64_tr_b16 v[36:37], v58 offset:8192
    ds_read_b64_tr_b16 v[38:39], v58 offset:8448
    v_mfma_f32_32x32x16_bf16 v[96:111], v[44:47], v[24:27], v[96:111]
    v_mfma_f32_32x32x16_bf16 v[112:127], v[44:47], v[28:31], v[112:127]
    v_mfma_f32_32x32x16_bf16 v[64:79], v[40:43], v[24:27], v[64:79]
    v_mfma_f32_32x32x16_bf16 v[80:95], v[40:43], v[28:31], v[80:95]
    s_waitcnt lgkmcnt(0)
    ds_read_b128 v[24:27], v51 offset:32768
    ds_read_b128 v[28:31], v51 offset:36864
    ds_read_b64_tr_b16 v[40:41], v55 offset:57856
    ds_read_b64_tr_b16 v[42:43], v55 offset:58752
    ds_read_b64_tr_b16 v[44:45], v59 offset:8192
    ds_read_b64_tr_b16 v[46:47], v59 offset:8448
    v_mfma_f32_32x32x16_bf16 v[96:111], v[36:39], v[16:19], v[96:111]
    v_mfma_f32_32x32x16_bf16 v[112:127], v[36:39], v[20:23], v[112:127]
    v_mfma_f32_32x32x16_bf16 v[64:79], v[32:35], v[16:19], v[64:79]
    v_mfma_f32_32x32x16_bf16 v[80:95], v[32:35], v[20:23], v[80:95]
    s_waitcnt lgkmcnt(0)
    s_waitcnt vmcnt(6)
    s_barrier
    ds_read_b128 v[16:19], v48 offset:0
    ds_read_b128 v[20:23], v48 offset:4096
    ds_read_b64_tr_b16 v[32:33], v52 offset:0
    ds_read_b64_tr_b16 v[34:35], v52 offset:896
    ds_read_b64_tr_b16 v[36:37], v56 offset:0
    ds_read_b64_tr_b16 v[38:39], v56 offset:256
    v_mfma_f32_32x32x16_bf16 v[96:111], v[44:47], v[24:27], v[96:111]
    s_add_u32 s63, s91, 5
    s_and_b32 s63, s63, 7
    s_lshl_b32 s60, s63, 7
    s_mul_i32 s61, s89, s63
    s_add_u32 m0, s64, 32768
    s_nop 0
    buffer_load_dwordx4 v4, s[28:31], s60 offen lds
    v_mfma_f32_32x32x16_bf16 v[112:127], v[44:47], v[28:31], v[112:127]
    s_add_u32 m0, s65, 32768
    s_nop 0
    buffer_load_dwordx4 v5, s[28:31], s60 offen lds
    v_mfma_f32_32x32x16_bf16 v[64:79], v[40:43], v[24:27], v[64:79]
    s_add_u32 m0, s66, s88
    s_nop 0
    buffer_load_dwordx4 v12, s[32:35], s61 offen lds
    v_mfma_f32_32x32x16_bf16 v[80:95], v[40:43], v[28:31], v[80:95]
    s_waitcnt lgkmcnt(0)
    ds_read_b128 v[24:27], v49 offset:0
    ds_read_b128 v[28:31], v49 offset:4096
    ds_read_b64_tr_b16 v[40:41], v53 offset:0
    ds_read_b64_tr_b16 v[42:43], v53 offset:896
    ds_read_b64_tr_b16 v[44:45], v57 offset:0
    ds_read_b64_tr_b16 v[46:47], v57 offset:256
    v_mfma_f32_32x32x16_bf16 v[96:111], v[36:39], v[16:19], v[96:111]
    s_add_u32 m0, s67, s88
    s_nop 0
    buffer_load_dwordx4 v13, s[32:35], s61 offen lds
    v_mfma_f32_32x32x16_bf16 v[112:127], v[36:39], v[20:23], v[112:127]
    s_add_u32 m0, s68, s88
    s_nop 0
    buffer_load_dwordx4 v14, s[36:39], s61 offen lds
    v_mfma_f32_32x32x16_bf16 v[64:79], v[32:35], v[16:19], v[64:79]
    s_add_u32 m0, s69, s88
    s_nop 0
    buffer_load_dwordx4 v15, s[36:39], s61 offen lds
    v_mfma_f32_32x32x16_bf16 v[80:95], v[32:35], v[20:23], v[80:95]
    s_waitcnt lgkmcnt(0)
    ds_read_b128 v[16:19], v50 offset:0
    ds_read_b128 v[20:23], v50 offset:4096
    ds_read_b64_tr_b16 v[32:33], v54 offset:0
    ds_read_b64_tr_b16 v[34:35], v54 offset:896
    ds_read_b64_tr_b16 v[36:37], v58 offset:0
    ds_read_b64_tr_b16 v[38:39], v58 offset:256
    v_mfma_f32_32x32x16_bf16 v[96:111], v[44:47], v[24:27], v[96:111]
    v_mfma_f32_32x32x16_bf16 v[112:127], v[44:47], v[28:31], v[112:127]
    v_mfma_f32_32x32x16_bf16 v[64:79], v[40:43], v[24:27], v[64:79]
    v_mfma_f32_32x32x16_bf16 v[80:95], v[40:43], v[28:31], v[80:95]
    s_waitcnt lgkmcnt(0)
    ds_read_b128 v[24:27], v51 offset:0
    ds_read_b128 v[28:31], v51 offset:4096
    ds_read_b64_tr_b16 v[40:41], v55 offset:0
    ds_read_b64_tr_b16 v[42:43], v55 offset:896
    ds_read_b64_tr_b16 v[44:45], v59 offset:0
    ds_read_b64_tr_b16 v[46:47], v59 offset:256
    v_mfma_f32_32x32x16_bf16 v[96:111], v[36:39], v[16:19], v[96:111]
    v_mfma_f32_32x32x16_bf16 v[112:127], v[36:39], v[20:23], v[112:127]
    v_mfma_f32_32x32x16_bf16 v[64:79], v[32:35], v[16:19], v[64:79]
    v_mfma_f32_32x32x16_bf16 v[80:95], v[32:35], v[20:23], v[80:95]
    s_waitcnt lgkmcnt(0)
    s_waitcnt vmcnt(6)
    s_barrier
    ds_read_b128 v[16:19], v48 offset:16384
    ds_read_b128 v[20:23], v48 offset:20480
    ds_read_b64_tr_b16 v[32:33], v52 offset:28928
    ds_read_b64_tr_b16 v[34:35], v52 offset:29824
    ds_read_b64_tr_b16 v[36:37], v56 offset:4096
    ds_read_b64_tr_b16 v[38:39], v56 offset:4352
    v_mfma_f32_32x32x16_bf16 v[96:111], v[44:47], v[24:27], v[96:111]
    s_add_u32 s63, s91, 6
    s_and_b32 s63, s63, 7
    s_lshl_b32 s60, s63, 7
    s_mul_i32 s61, s89, s63
    s_add_u32 m0, s64, 0
    s_nop 0
    buffer_load_dwordx4 v4, s[28:31], s60 offen lds
    v_mfma_f32_32x32x16_bf16 v[112:127], v[44:47], v[28:31], v[112:127]
    s_add_u32 m0, s65, 0
    s_nop 0
    buffer_load_dwordx4 v5, s[28:31], s60 offen lds
    v_mfma_f32_32x32x16_bf16 v[64:79], v[40:43], v[24:27], v[64:79]
    s_add_u32 m0, s66, 0
    s_nop 0
    buffer_load_dwordx4 v12, s[32:35], s61 offen lds
    v_mfma_f32_32x32x16_bf16 v[80:95], v[40:43], v[28:31], v[80:95]
    s_waitcnt lgkmcnt(0)
    ds_read_b128 v[24:27], v49 offset:16384
    ds_read_b128 v[28:31], v49 offset:20480
    ds_read_b64_tr_b16 v[40:41], v53 offset:28928
    ds_read_b64_tr_b16 v[42:43], v53 offset:29824
    ds_read_b64_tr_b16 v[44:45], v57 offset:4096
    ds_read_b64_tr_b16 v[46:47], v57 offset:4352
    v_mfma_f32_32x32x16_bf16 v[96:111], v[36:39], v[16:19], v[96:111]
    s_add_u32 m0, s67, 0
    s_nop 0
    buffer_load_dwordx4 v13, s[32:35], s61 offen lds
    v_mfma_f32_32x32x16_bf16 v[112:127], v[36:39], v[20:23], v[112:127]
    s_add_u32 m0, s68, 0
    s_nop 0
    buffer_load_dwordx4 v14, s[36:39], s61 offen lds
    v_mfma_f32_32x32x16_bf16 v[64:79], v[32:35], v[16:19], v[64:79]
    s_add_u32 m0, s69, 0
    s_nop 0
    buffer_load_dwordx4 v15, s[36:39], s61 offen lds
    v_mfma_f32_32x32x16_bf16 v[80:95], v[32:35], v[20:23], v[80:95]
    s_waitcnt lgkmcnt(0)
    ds_read_b128 v[16:19], v50 offset:16384
    ds_read_b128 v[20:23], v50 offset:20480
    ds_read_b64_tr_b16 v[32:33], v54 offset:28928
    ds_read_b64_tr_b16 v[34:35], v54 offset:29824
    ds_read_b64_tr_b16 v[36:37], v58 offset:4096
    ds_read_b64_tr_b16 v[38:39], v58 offset:4352
    v_mfma_f32_32x32x16_bf16 v[96:111], v[44:47], v[24:27], v[96:111]
    v_mfma_f32_32x32x16_bf16 v[112:127], v[44:47], v[28:31], v[112:127]
    v_mfma_f32_32x32x16_bf16 v[64:79], v[40:43], v[24:27], v[64:79]
    v_mfma_f32_32x32x16_bf16 v[80:95], v[40:43], v[28:31], v[80:95]
    s_waitcnt lgkmcnt(0)
    ds_read_b128 v[24:27], v51 offset:16384
    ds_read_b128 v[28:31], v51 offset:20480
    ds_read_b64_tr_b16 v[40:41], v55 offset:28928
    ds_read_b64_tr_b16 v[42:43], v55 offset:29824
    ds_read_b64_tr_b16 v[44:45], v59 offset:4096
    ds_read_b64_tr_b16 v[46:47], v59 offset:4352
    v_mfma_f32_32x32x16_bf16 v[96:111], v[36:39], v[16:19], v[96:111]
    v_mfma_f32_32x32x16_bf16 v[112:127], v[36:39], v[20:23], v[112:127]
    v_mfma_f32_32x32x16_bf16 v[64:79], v[32:35], v[16:19], v[64:79]
    v_mfma_f32_32x32x16_bf16 v[80:95], v[32:35], v[20:23], v[80:95]
    s_waitcnt lgkmcnt(0)
    s_waitcnt vmcnt(6)
    s_barrier
    ds_read_b128 v[16:19], v48 offset:32768
    ds_read_b128 v[20:23], v48 offset:36864
    ds_read_b64_tr_b16 v[32:33], v52 offset:57856
    ds_read_b64_tr_b16 v[34:35], v52 offset:58752
    ds_read_b64_tr_b16 v[36:37], v56 offset:8192
    ds_read_b64_tr_b16 v[38:39], v56 offset:8448
    v_mfma_f32_32x32x16_bf16 v[96:111], v[44:47], v[24:27], v[96:111]
    s_add_u32 s63, s91, 7
    s_and_b32 s63, s63, 7
    s_lshl_b32 s60, s63, 7
    s_mul_i32 s61, s89, s63
    s_add_u32 m0, s64, 16384
    s_nop 0
    buffer_load_dwordx4 v4, s[28:31], s60 offen lds
    v_mfma_f32_32x32x16_bf16 v[112:127], v[44:47], v[28:31], v[112:127]
    s_add_u32 m0, s65, 16384
    s_nop 0
    buffer_load_dwordx4 v5, s[28:31], s60 offen lds
    v_mfma_f32_32x32x16_bf16 v[64:79], v[40:43], v[24:27], v[64:79]
    s_add_u32 m0, s66, s87
    s_nop 0
    buffer_load_dwordx4 v12, s[32:35], s61 offen lds
    v_mfma_f32_32x32x16_bf16 v[80:95], v[40:43], v[28:31], v[80:95]
    s_waitcnt lgkmcnt(0)
    ds_read_b128 v[24:27], v49 offset:32768
    ds_read_b128 v[28:31], v49 offset:36864
    ds_read_b64_tr_b16 v[40:41], v53 offset:57856
    ds_read_b64_tr_b16 v[42:43], v53 offset:58752
    ds_read_b64_tr_b16 v[44:45], v57 offset:8192
    ds_read_b64_tr_b16 v[46:47], v57 offset:8448
    v_mfma_f32_32x32x16_bf16 v[96:111], v[36:39], v[16:19], v[96:111]
    s_add_u32 m0, s67, s87
    s_nop 0
    buffer_load_dwordx4 v13, s[32:35], s61 offen lds
    v_mfma_f32_32x32x16_bf16 v[112:127], v[36:39], v[20:23], v[112:127]
    s_add_u32 m0, s68, s87
    s_nop 0
    buffer_load_dwordx4 v14, s[36:39], s61 offen lds
    v_mfma_f32_32x32x16_bf16 v[64:79], v[32:35], v[16:19], v[64:79]
    s_add_u32 m0, s69, s87
    s_nop 0
    buffer_load_dwordx4 v15, s[36:39], s61 offen lds
    v_mfma_f32_32x32x16_bf16 v[80:95], v[32:35], v[20:23], v[80:95]
    s_waitcnt lgkmcnt(0)
    ds_read_b128 v[16:19], v50 offset:32768
    ds_read_b128 v[20:23], v50 offset:36864
    ds_read_b64_tr_b16 v[32:33], v54 offset:57856
    ds_read_b64_tr_b16 v[34:35], v54 offset:58752
    ds_read_b64_tr_b16 v[36:37], v58 offset:8192
    ds_read_b64_tr_b16 v[38:39], v58 offset:8448
    v_mfma_f32_32x32x16_bf16 v[96:111], v[44:47], v[24:27], v[96:111]
    v_mfma_f32_32x32x16_bf16 v[112:127], v[44:47], v[28:31], v[112:127]
    v_mfma_f32_32x32x16_bf16 v[64:79], v[40:43], v[24:27], v[64:79]
    v_mfma_f32_32x32x16_bf16 v[80:95], v[40:43], v[28:31], v[80:95]
    s_waitcnt lgkmcnt(0)
    ds_read_b128 v[24:27], v51 offset:32768
    ds_read_b128 v[28:31], v51 offset:36864
    ds_read_b64_tr_b16 v[40:41], v55 offset:57856
    ds_read_b64_tr_b16 v[42:43], v55 offset:58752
    ds_read_b64_tr_b16 v[44:45], v59 offset:8192
    ds_read_b64_tr_b16 v[46:47], v59 offset:8448
    v_mfma_f32_32x32x16_bf16 v[96:111], v[36:39], v[16:19], v[96:111]
    v_mfma_f32_32x32x16_bf16 v[112:127], v[36:39], v[20:23], v[112:127]
    v_mfma_f32_32x32x16_bf16 v[64:79], v[32:35], v[16:19], v[64:79]
    v_mfma_f32_32x32x16_bf16 v[80:95], v[32:35], v[20:23], v[80:95]
    s_waitcnt lgkmcnt(0)
    s_waitcnt vmcnt(6)
    s_barrier
    ds_read_b128 v[16:19], v48 offset:0
    ds_read_b128 v[20:23], v48 offset:4096
    ds_read_b64_tr_b16 v[32:33], v52 offset:0
    ds_read_b64_tr_b16 v[34:35], v52 offset:896
    ds_read_b64_tr_b16 v[36:37], v56 offset:0
    ds_read_b64_tr_b16 v[38:39], v56 offset:256
    v_mfma_f32_32x32x16_bf16 v[96:111], v[44:47], v[24:27], v[96:111]
    v_mfma_f32_32x32x16_bf16 v[112:127], v[44:47], v[28:31], v[112:127]
    v_mfma_f32_32x32x16_bf16 v[64:79], v[40:43], v[24:27], v[64:79]
    v_mfma_f32_32x32x16_bf16 v[80:95], v[40:43], v[28:31], v[80:95]
    s_waitcnt lgkmcnt(0)
    ds_read_b128 v[24:27], v49 offset:0
    ds_read_b128 v[28:31], v49 offset:4096
    ds_read_b64_tr_b16 v[40:41], v53 offset:0
    ds_read_b64_tr_b16 v[42:43], v53 offset:896
    ds_read_b64_tr_b16 v[44:45], v57 offset:0
    ds_read_b64_tr_b16 v[46:47], v57 offset:256
    v_mfma_f32_32x32x16_bf16 v[96:111], v[36:39], v[16:19], v[96:111]
    v_mfma_f32_32x32x16_bf16 v[112:127], v[36:39], v[20:23], v[112:127]
    v_mfma_f32_32x32x16_bf16 v[64:79], v[32:35], v[16:19], v[64:79]
    v_mfma_f32_32x32x16_bf16 v[80:95], v[32:35], v[20:23], v[80:95]
    s_waitcnt lgkmcnt(0)
    ds_read_b128 v[16:19], v50 offset:0
    ds_read_b128 v[20:23], v50 offset:4096
    ds_read_b64_tr_b16 v[32:33], v54 offset:0
    ds_read_b64_tr_b16 v[34:35], v54 offset:896
    ds_read_b64_tr_b16 v[36:37], v58 offset:0
    ds_read_b64_tr_b16 v[38:39], v58 offset:256
    v_mfma_f32_32x32x16_bf16 v[96:111], v[44:47], v[24:27], v[96:111]
    v_mfma_f32_32x32x16_bf16 v[112:127], v[44:47], v[28:31], v[112:127]
    v_mfma_f32_32x32x16_bf16 v[64:79], v[40:43], v[24:27], v[64:79]
    v_mfma_f32_32x32x16_bf16 v[80:95], v[40:43], v[28:31], v[80:95]
    s_waitcnt lgkmcnt(0)
    ds_read_b128 v[24:27], v51 offset:0
    ds_read_b128 v[28:31], v51 offset:4096
    ds_read_b64_tr_b16 v[40:41], v55 offset:0
    ds_read_b64_tr_b16 v[42:43], v55 offset:896
    ds_read_b64_tr_b16 v[44:45], v59 offset:0
    ds_read_b64_tr_b16 v[46:47], v59 offset:256
    v_mfma_f32_32x32x16_bf16 v[96:111], v[36:39], v[16:19], v[96:111]
    v_mfma_f32_32x32x16_bf16 v[112:127], v[36:39], v[20:23], v[112:127]
    v_mfma_f32_32x32x16_bf16 v[64:79], v[32:35], v[16:19], v[64:79]
    v_mfma_f32_32x32x16_bf16 v[80:95], v[32:35], v[20:23], v[80:95]
    s_waitcnt lgkmcnt(0)
    s_waitcnt vmcnt(0)
    s_barrier
    ds_read_b128 v[16:19], v48 offset:16384
    ds_read_b128 v[20:23], v48 offset:20480
    ds_read_b64_tr_b16 v[32:33], v52 offset:28928
    ds_read_b64_tr_b16 v[34:35], v52 offset:29824
    ds_read_b64_tr_b16 v[36:37], v56 offset:4096
    ds_read_b64_tr_b16 v[38:39], v56 offset:4352
    v_mfma_f32_32x32x16_bf16 v[96:111], v[44:47], v[24:27], v[96:111]
    v_mfma_f32_32x32x16_bf16 v[112:127], v[44:47], v[28:31], v[112:127]
    v_mfma_f32_32x32x16_bf16 v[64:79], v[40:43], v[24:27], v[64:79]
    v_mfma_f32_32x32x16_bf16 v[80:95], v[40:43], v[28:31], v[80:95]
    s_waitcnt lgkmcnt(0)
    ds_read_b128 v[24:27], v49 offset:16384
    ds_read_b128 v[28:31], v49 offset:20480
    ds_read_b64_tr_b16 v[40:41], v53 offset:28928
    ds_read_b64_tr_b16 v[42:43], v53 offset:29824
    ds_read_b64_tr_b16 v[44:45], v57 offset:4096
    ds_read_b64_tr_b16 v[46:47], v57 offset:4352
    ds_read_b64 v[148:149], v61 offset:0
    ds_read_b64 v[152:153], v61 offset:8
    ds_read2_b32 v[156:157], v62 offset0:0 offset1:0
    ds_read2_b32 v[160:161], v62 offset0:64 offset1:64
    ds_read2_b32 v[140:141], v62 offset0:1 offset1:65
    v_mfma_f32_32x32x16_bf16 v[96:111], v[36:39], v[16:19], v[96:111]
    v_mfma_f32_32x32x16_bf16 v[112:127], v[36:39], v[20:23], v[112:127]
    v_mfma_f32_32x32x16_bf16 v[64:79], v[32:35], v[16:19], v[64:79]
    v_mfma_f32_32x32x16_bf16 v[80:95], v[32:35], v[20:23], v[80:95]
    s_waitcnt lgkmcnt(0)
    ds_read_b128 v[16:19], v50 offset:16384
    ds_read_b128 v[20:23], v50 offset:20480
    ds_read_b64_tr_b16 v[32:33], v54 offset:28928
    ds_read_b64_tr_b16 v[34:35], v54 offset:29824
    ds_read_b64_tr_b16 v[36:37], v58 offset:4096
    ds_read_b64_tr_b16 v[38:39], v58 offset:4352
    v_mfma_f32_32x32x16_bf16 v[96:111], v[44:47], v[24:27], v[96:111]
    v_mfma_f32_32x32x16_bf16 v[112:127], v[44:47], v[28:31], v[112:127]
    v_mfma_f32_32x32x16_bf16 v[64:79], v[40:43], v[24:27], v[64:79]
    v_mfma_f32_32x32x16_bf16 v[80:95], v[40:43], v[28:31], v[80:95]
    v_mfma_f32_32x32x16_bf16 v[96:111], v[152:155], v[156:159], v[96:111]
    v_mfma_f32_32x32x16_bf16 v[112:127], v[152:155], v[160:163], v[112:127]
    v_mfma_f32_32x32x16_bf16 v[64:79], v[148:151], v[156:159], v[64:79]
    v_mfma_f32_32x32x16_bf16 v[80:95], v[148:151], v[160:163], v[80:95]
    s_waitcnt lgkmcnt(0)
    ds_read_b128 v[24:27], v51 offset:16384
    ds_read_b128 v[28:31], v51 offset:20480
    ds_read_b64_tr_b16 v[40:41], v55 offset:28928
    ds_read_b64_tr_b16 v[42:43], v55 offset:29824
    ds_read_b64_tr_b16 v[44:45], v59 offset:4096
    ds_read_b64_tr_b16 v[46:47], v59 offset:4352
    v_mfma_f32_32x32x16_bf16 v[96:111], v[36:39], v[16:19], v[96:111]
    v_mfma_f32_32x32x16_bf16 v[112:127], v[36:39], v[20:23], v[112:127]
    v_mfma_f32_32x32x16_bf16 v[64:79], v[32:35], v[16:19], v[64:79]
    v_mfma_f32_32x32x16_bf16 v[80:95], v[32:35], v[20:23], v[80:95]
    s_lshl_b32 s59, s57, 2
    s_lshl_b32 s60, s70, 1
    s_add_u32 s59, s59, s60
    s_mul_i32 s60, s59, 112
    s_mul_i32 s61, s58, 7
    s_add_u32 s60, s60, s61
    s_lshl_b32 s61, s71, 1
    s_add_u32 s60, s60, s61
    s_lshl_b32 s60, s60, 10
    s_add_u32 s60, s60, 8912896
    v_mul_f32 v140, 1052289595, v140
    v_mul_f32 v141, 1052289595, v141
    s_lshl_b32 s61, s70, 12
    s_add_u32 s61, s61, 151552
    v_add_u32 v142, s61, v144
    s_waitcnt lgkmcnt(0)
    v_mfma_f32_32x32x16_bf16 v[96:111], v[44:47], v[24:27], v[96:111]
    v_mfma_f32_32x32x16_bf16 v[112:127], v[44:47], v[28:31], v[112:127]
    v_mfma_f32_32x32x16_bf16 v[64:79], v[40:43], v[24:27], v[64:79]
    v_mfma_f32_32x32x16_bf16 v[80:95], v[40:43], v[28:31], v[80:95]
    s_nop 8
    v_mul_f32 v96, v140, v96
    v_mul_f32 v97, v140, v97
    v_cvt_pk_bf16_f32 v16, v96, v97
    v_mul_f32 v98, v140, v98
    v_mul_f32 v99, v140, v99
    v_cvt_pk_bf16_f32 v17, v98, v99
    v_mul_f32 v100, v140, v100
    v_mul_f32 v101, v140, v101
    v_cvt_pk_bf16_f32 v18, v100, v101
    v_mul_f32 v102, v140, v102
    v_mul_f32 v103, v140, v103
    v_cvt_pk_bf16_f32 v19, v102, v103
    v_mul_f32 v104, v140, v104
    v_mul_f32 v105, v140, v105
    v_cvt_pk_bf16_f32 v20, v104, v105
    v_mul_f32 v106, v140, v106
    v_mul_f32 v107, v140, v107
    v_cvt_pk_bf16_f32 v21, v106, v107
    v_mul_f32 v108, v140, v108
    v_mul_f32 v109, v140, v109
    v_cvt_pk_bf16_f32 v22, v108, v109
    v_mul_f32 v110, v140, v110
    v_mul_f32 v111, v140, v111
    v_cvt_pk_bf16_f32 v23, v110, v111
    ds_write_b128 v142, v[16:19] offset:0
    ds_write_b128 v142, v[20:23] offset:1024
    v_mul_f32 v112, v141, v112
    v_mul_f32 v113, v141, v113
    v_cvt_pk_bf16_f32 v32, v112, v113
    v_mul_f32 v114, v141, v114
    v_mul_f32 v115, v141, v115
    v_cvt_pk_bf16_f32 v33, v114, v115
    v_mul_f32 v116, v141, v116
    v_mul_f32 v117, v141, v117
    v_cvt_pk_bf16_f32 v34, v116, v117
    v_mul_f32 v118, v141, v118
    v_mul_f32 v119, v141, v119
    v_cvt_pk_bf16_f32 v35, v118, v119
    v_mul_f32 v120, v141, v120
    v_mul_f32 v121, v141, v121
    v_cvt_pk_bf16_f32 v36, v120, v121
    v_mul_f32 v122, v141, v122
    v_mul_f32 v123, v141, v123
    v_cvt_pk_bf16_f32 v37, v122, v123
    v_mul_f32 v124, v141, v124
    v_mul_f32 v125, v141, v125
    v_cvt_pk_bf16_f32 v38, v124, v125
    v_mul_f32 v126, v141, v126
    v_mul_f32 v127, v141, v127
    v_cvt_pk_bf16_f32 v39, v126, v127
    ds_write_b128 v142, v[32:35] offset:2048
    ds_write_b128 v142, v[36:39] offset:3072
    v_max_f32 v64, 0, v64
    v_max_f32 v65, 0, v65
    v_max_f32 v66, 0, v66
    v_max_f32 v67, 0, v67
    v_max_f32 v68, 0, v68
    v_max_f32 v69, 0, v69
    v_max_f32 v70, 0, v70
    v_max_f32 v71, 0, v71
    v_mul_f32 v64, v64, v72
    v_mul_f32 v65, v65, v73
    v_cvt_pk_bf16_f32 v60, v64, v65
    v_mul_f32 v66, v66, v74
    v_mul_f32 v67, v67, v75
    v_cvt_pk_bf16_f32 v61, v66, v67
    v_mul_f32 v68, v68, v76
    v_mul_f32 v69, v69, v77
    v_cvt_pk_bf16_f32 v62, v68, v69
    v_mul_f32 v70, v70, v78
    v_mul_f32 v71, v71, v79
    v_cvt_pk_bf16_f32 v63, v70, v71
    s_add_u32 s62, s60, 0
    buffer_store_dwordx4 v[60:63], v144, s[40:43], s62 offen offset:0 sc1
    v_max_f32 v80, 0, v80
    v_max_f32 v81, 0, v81
    v_max_f32 v82, 0, v82
    v_max_f32 v83, 0, v83
    v_max_f32 v84, 0, v84
    v_max_f32 v85, 0, v85
    v_max_f32 v86, 0, v86
    v_max_f32 v87, 0, v87
    v_mul_f32 v80, v80, v88
    v_mul_f32 v81, v81, v89
    v_cvt_pk_bf16_f32 v48, v80, v81
    v_mul_f32 v82, v82, v90
    v_mul_f32 v83, v83, v91
    v_cvt_pk_bf16_f32 v49, v82, v83
    v_mul_f32 v84, v84, v92
    v_mul_f32 v85, v85, v93
    v_cvt_pk_bf16_f32 v50, v84, v85
    v_mul_f32 v86, v86, v94
    v_mul_f32 v87, v87, v95
    v_cvt_pk_bf16_f32 v51, v86, v87
    s_add_u32 s62, s60, 114688
    buffer_store_dwordx4 v[48:51], v144, s[40:43], s62 offen offset:0 sc1
.Lattn:
    s_lshr_b32 s69, s56, 2
    s_and_b32 s70, s56, 3
    v_and_b32 v2, 31, v1
    v_lshrrev_b32 v3, 5, v1
    v_lshlrev_b32 v14, 4, v2
    v_lshl_add_u32 v14, v3, 8, v14
    v_add_u32 v14, 1024, v14
    v_add_u32 v15, 512, v14
    v_and_b32 v3, 27, v2
    v_mov_b32 v12, 2064
    v_cmp_eq_u32 vcc, 16, v3
    v_mov_b32 v13, 2048
    s_cmp_eq_u32 s69, 0
    v_cndmask_b32 v12, v12, v13, vcc
    v_cmp_gt_u32 vcc, 16, v2
    s_cselect_b32 s71, 33280, 0
    s_cselect_b32 s66, 6, 2
    v_cndmask_b32 v14, v12, v14, vcc
    v_cndmask_b32 v15, v12, v15, vcc
    v_add_u32 v12, s71, v144
    v_add_u32 v13, s71, v14
    v_add_u32 v145, s71, v15
    s_lshl_b32 s59, s70, 11
    s_add_u32 s59, s59, 151552
    v_add_u32 v2, s59, v144
    v_cmp_gt_u32 vcc, 32, v1
    v_mov_b32 v3, 0x3f80
    v_mov_b32 v132, 0
    v_mov_b32 v160, 0
    v_mov_b32 v133, 0
    v_mov_b32 v161, 0
    v_mov_b32 v134, 0
    v_mov_b32 v162, 0
    v_mov_b32 v135, 0
    v_mov_b32 v163, 0
    v_cndmask_b32 v128, 0, v3, vcc
    v_mov_b32 v129, 0
    v_mov_b32 v131, 0
    v_mov_b32 v147, 0
    v_mfma_f32_32x32x16_bf16 v[96:111], v[132:135], v[132:135], 0
    v_mfma_f32_32x32x16_bf16 v[112:127], v[132:135], v[132:135], 0
    v_mfma_f32_32x32x16_bf16 v[80:95], v[132:135], v[132:135], 0
    v_mov_b32 v135, 0xdddddddd
    s_cmp_eq_u32 s69, 0
    s_cbranch_scc0 .Lnobe2
    s_setprio 1
    s_waitcnt lgkmcnt(0)
    s_barrier
.Lnobe2:
    ds_read_b128 v[4:7], v2
    ds_read_b128 v[8:11], v2 offset:1024
    s_mul_i32 s59, s70, 4608
    s_add_u32 s81, s59, 133120
    s_lshl_b32 s82, s70, 2
    s_add_u32 s82, s82, 160256
    s_lshl_b32 s80, s57, 2
    s_add_u32 s80, s80, s70
    s_lshl_b32 s80, s80, 5
    s_lshl_b32 s60, s58, 1
    s_add_u32 s80, s80, s60
    s_lshl_b32 s80, s80, 10
    s_add_u32 s80, s80, 2359296
    s_lshl_b32 s85, s57, 4
    s_add_u32 s85, s85, s58
    s_lshl_b32 s85, s85, 9
    s_lshl_b32 s60, s70, 7
    s_add_u32 s85, s85, s60
    s_add_u32 s85, s85, 1179648
    s_lshl_b32 s59, s70, 9
    s_add_u32 s59, s59, 160768
    v_lshl_add_u32 v164, v1, 3, s59
    v_mov_b32 v165, s82
    s_mov_b32 s67, 0
    s_cmp_eq_u32 s69, 0
    s_cbranch_scc1 .Lhv1
    v_mov_b32 v3, 160304
.Llw1:
    ds_read_b128 v[148:151], v3
    s_waitcnt lgkmcnt(0)
    v_and_b32 v148, v148, v149
    v_and_b32 v150, v150, v151
    v_and_b32 v148, v148, v150
    s_nop 0
    v_readfirstlane_b32 s59, v148
    s_cmp_eq_u32 s59, 1
    s_cbranch_scc1 .Llwok2
    s_sleep 2
    s_branch .Llw1
.Llwok2:
    v_add_u32 v3, 16, v165
.Llv3:
    ds_read_b32 v148, v3
    s_waitcnt lgkmcnt(0)
    v_readfirstlane_b32 s59, v148
    s_cmp_lg_u32 s59, 0
    s_cbranch_scc1 .Llvok4
    s_sleep 1
    s_branch .Llv3
.Llvok4:
    ds_read_b32 v130, v164
    ds_read_b32 v146, v164 offset:4
    ds_read_b128 v[136:139], v12
    ds_read_b128 v[140:143], v12 offset:2080
    ds_read_b128 v[148:151], v13
    ds_read_b128 v[152:155], v145
    v_mov_b32 v2, 160324
    v_mov_b32 v3, 1
    s_mov_b32 s68, s66
    s_waitcnt lgkmcnt(4)
    v_mfma_f32_32x32x8_bf16 v[16:31], v[128:129], v[130:131], 0
    v_mfma_f32_32x32x8_bf16 v[32:47], v[128:129], v[146:147], 0
    s_waitcnt vmcnt(0)
    s_mov_b64 exec, 1
    ds_add_u32 v2, v3
    s_mov_b64 exec, -1
    s_setprio 0
    s_waitcnt lgkmcnt(0)
    s_nop 2
    v_mfma_f32_32x32x16_bf16 v[64:79], v[136:139], v[4:7], v[16:31]
    s_nop 10
    s_branch .Lhv2
.Lhv1:
    ds_read_b128 v[136:139], v12
    ds_read_b128 v[140:143], v12 offset:2080
    ds_read_b128 v[148:151], v13
    ds_read_b128 v[152:155], v145
    s_waitcnt lgkmcnt(3)
    v_mfma_f32_32x32x16_bf16 v[64:79], v[136:139], v[4:7], 0
    s_waitcnt lgkmcnt(2)
    v_mfma_f32_32x32x16_bf16 v[80:95], v[140:143], v[4:7], 0
    v_mfma_f32_32x32x16_bf16 v[16:31], v[136:139], v[8:11], 0
    v_mfma_f32_32x32x16_bf16 v[32:47], v[140:143], v[8:11], 0
    s_mov_b32 s68, 1120403456
    s_nop 6
    v_max_f32 v2, v64, v65
    v_max3_f32 v2, v66, v67, v2
    v_max3_f32 v2, v68, v69, v2
    v_max3_f32 v2, v70, v71, v2
    v_max3_f32 v2, v72, v73, v2
    v_max3_f32 v2, v74, v75, v2
    v_max3_f32 v2, v76, v77, v2
    v_max3_f32 v2, v78, v79, v2
    v_max3_f32 v2, v80, v81, v2
    v_max3_f32 v2, v82, v83, v2
    v_max3_f32 v2, v84, v85, v2
    v_max3_f32 v2, v86, v87, v2
    v_max3_f32 v2, v88, v89, v2
    v_max3_f32 v2, v90, v91, v2
    v_max3_f32 v2, v92, v93, v2
    v_max3_f32 v2, v94, v95, v2
    v_max_f32 v3, v16, v17
    v_mov_b32 v146, v2
    v_max3_f32 v3, v18, v19, v3
    v_max3_f32 v3, v20, v21, v3
    v_permlane32_swap_b32 v2, v146
    v_max3_f32 v3, v22, v23, v3
    v_max_f32 v2, v2, v146
    v_max3_f32 v3, v24, v25, v3
    v_add_f32 v2, s68, v2
    v_max3_f32 v3, v26, v27, v3
    v_cvt_pk_bf16_f32 v130, -v2, 0
    v_max3_f32 v3, v28, v29, v3
    v_max3_f32 v3, v30, v31, v3
    v_max3_f32 v3, v32, v33, v3
    v_mfma_f32_32x32x8_bf16 v[16:31], v[128:129], v[130:131], 0
    v_max3_f32 v3, v34, v35, v3
    v_max3_f32 v3, v36, v37, v3
    v_max3_f32 v3, v38, v39, v3
    v_max3_f32 v3, v40, v41, v3
    v_max3_f32 v3, v42, v43, v3
    v_max3_f32 v3, v44, v45, v3
    v_max3_f32 v3, v46, v47, v3
    v_mov_b32 v146, v3
    v_mov_b32 v2, 160324
    s_waitcnt lgkmcnt(0)
    v_permlane32_swap_b32 v3, v146
    v_mfma_f32_32x32x16_bf16 v[64:79], v[136:139], v[4:7], v[16:31]
    v_max_f32 v3, v3, v146
    v_add_f32 v3, s68, v3
    v_cvt_pk_bf16_f32 v146, -v3, 0
    v_mov_b32 v3, 1
    s_mov_b32 s68, 1
    v_mfma_f32_32x32x8_bf16 v[32:47], v[128:129], v[146:147], 0
    ds_write2_b32 v164, v130, v146 offset0:0 offset1:1
    ds_write_b32 v165, v3 offset:16
    s_waitcnt vmcnt(0)
    s_mov_b64 exec, 1
    ds_add_u32 v2, v3
    s_mov_b64 exec, -1
.Lhv2:
.Lloop:
    v_exp_f32 v64, v64
    v_exp_f32 v65, v65
    v_smfmac_f32_32x32x32_bf16 v[112:127], v[160:163], v[88:95], v135
    ds_read_b128 v[156:159], v13 offset:2080
    ds_read_b128 v[160:163], v145 offset:2080
    v_exp_f32 v66, v66
    v_exp_f32 v67, v67
    v_exp_f32 v68, v68
    v_mfma_f32_32x32x16_bf16 v[80:95], v[136:139], v[8:11], v[32:47]
    ds_read_b128 v[136:139], v12 offset:4160
    v_exp_f32 v69, v69
    v_exp_f32 v70, v70
    v_exp_f32 v71, v71
    v_exp_f32 v72, v72
    v_exp_f32 v73, v73
    v_exp_f32 v74, v74
    v_smfmac_f32_32x32x32_bf16 v[96:111], v[148:151], v[64:71], v135
    v_exp_f32 v75, v75
    v_exp_f32 v76, v76
    v_exp_f32 v77, v77
    v_exp_f32 v78, v78
    v_exp_f32 v79, v79
    v_exp_f32 v80, v80
    v_exp_f32 v81, v81
    v_smfmac_f32_32x32x32_bf16 v[96:111], v[152:155], v[72:79], v135
    v_exp_f32 v82, v82
    v_exp_f32 v83, v83
    v_exp_f32 v84, v84
    v_mfma_f32_32x32x16_bf16 v[64:79], v[140:143], v[4:7], v[16:31]
    v_exp_f32 v85, v85
    v_exp_f32 v86, v86
    v_exp_f32 v87, v87
    v_exp_f32 v88, v88
    v_exp_f32 v89, v89
    v_exp_f32 v90, v90
    v_smfmac_f32_32x32x32_bf16 v[112:127], v[148:151], v[80:87], v135
    s_waitcnt lgkmcnt(0)
    v_exp_f32 v91, v91
    v_exp_f32 v92, v92
    v_exp_f32 v93, v93
    v_exp_f32 v94, v94
    v_exp_f32 v95, v95
    v_exp_f32 v64, v64
    v_exp_f32 v65, v65
    v_smfmac_f32_32x32x32_bf16 v[112:127], v[152:155], v[88:95], v135
    ds_read_b128 v[148:151], v13 offset:4160
    ds_read_b128 v[152:155], v145 offset:4160
    v_exp_f32 v66, v66
    v_exp_f32 v67, v67
    v_exp_f32 v68, v68
    v_mfma_f32_32x32x16_bf16 v[80:95], v[140:143], v[8:11], v[32:47]
    ds_read_b128 v[140:143], v12 offset:6240
    v_exp_f32 v69, v69
    v_exp_f32 v70, v70
    v_exp_f32 v71, v71
    v_exp_f32 v72, v72
    v_exp_f32 v73, v73
    v_exp_f32 v74, v74
    v_smfmac_f32_32x32x32_bf16 v[96:111], v[156:159], v[64:71], v135
    v_exp_f32 v75, v75
    v_exp_f32 v76, v76
    v_exp_f32 v77, v77
    v_exp_f32 v78, v78
    v_exp_f32 v79, v79
    v_exp_f32 v80, v80
    v_exp_f32 v81, v81
    v_smfmac_f32_32x32x32_bf16 v[96:111], v[160:163], v[72:79], v135
    v_exp_f32 v82, v82
    v_exp_f32 v83, v83
    v_exp_f32 v84, v84
    v_mfma_f32_32x32x16_bf16 v[64:79], v[136:139], v[4:7], v[16:31]
    v_exp_f32 v85, v85
    v_exp_f32 v86, v86
    v_exp_f32 v87, v87
    v_exp_f32 v88, v88
    v_exp_f32 v89, v89
    v_exp_f32 v90, v90
    v_smfmac_f32_32x32x32_bf16 v[112:127], v[156:159], v[80:87], v135
    s_waitcnt lgkmcnt(0)
    v_exp_f32 v91, v91
    v_exp_f32 v92, v92
    v_exp_f32 v93, v93
    v_exp_f32 v94, v94
    v_exp_f32 v95, v95
    v_exp_f32 v64, v64
    v_exp_f32 v65, v65
    v_smfmac_f32_32x32x32_bf16 v[112:127], v[160:163], v[88:95], v135
    ds_read_b128 v[156:159], v13 offset:6240
    ds_read_b128 v[160:163], v145 offset:6240
    v_exp_f32 v66, v66
    v_exp_f32 v67, v67
    v_exp_f32 v68, v68
    v_mfma_f32_32x32x16_bf16 v[80:95], v[136:139], v[8:11], v[32:47]
    ds_read_b128 v[136:139], v12 offset:8320
    v_exp_f32 v69, v69
    v_exp_f32 v70, v70
    v_exp_f32 v71, v71
    v_exp_f32 v72, v72
    v_exp_f32 v73, v73
    v_exp_f32 v74, v74
    v_smfmac_f32_32x32x32_bf16 v[96:111], v[148:151], v[64:71], v135
    v_exp_f32 v75, v75
    v_exp_f32 v76, v76
    v_exp_f32 v77, v77
    v_exp_f32 v78, v78
    v_exp_f32 v79, v79
    v_exp_f32 v80, v80
    v_exp_f32 v81, v81
    v_smfmac_f32_32x32x32_bf16 v[96:111], v[152:155], v[72:79], v135
    v_exp_f32 v82, v82
    v_exp_f32 v83, v83
    v_exp_f32 v84, v84
    v_mfma_f32_32x32x16_bf16 v[64:79], v[140:143], v[4:7], v[16:31]
    v_exp_f32 v85, v85
    v_exp_f32 v86, v86
    v_exp_f32 v87, v87
    v_exp_f32 v88, v88
    v_exp_f32 v89, v89
    v_exp_f32 v90, v90
    v_smfmac_f32_32x32x32_bf16 v[112:127], v[148:151], v[80:87], v135
    s_waitcnt lgkmcnt(0)
    v_exp_f32 v91, v91
    v_exp_f32 v92, v92
    v_exp_f32 v93, v93
    v_exp_f32 v94, v94
    v_exp_f32 v95, v95
    v_exp_f32 v64, v64
    v_exp_f32 v65, v65
    v_smfmac_f32_32x32x32_bf16 v[112:127], v[152:155], v[88:95], v135
    ds_read_b128 v[148:151], v13 offset:8320
    ds_read_b128 v[152:155], v145 offset:8320
    v_exp_f32 v66, v66
    v_exp_f32 v67, v67
    v_exp_f32 v68, v68
    v_mfma_f32_32x32x16_bf16 v[80:95], v[140:143], v[8:11], v[32:47]
    ds_read_b128 v[140:143], v12 offset:10400
    v_exp_f32 v69, v69
    v_exp_f32 v70, v70
    v_exp_f32 v71, v71
    v_exp_f32 v72, v72
    v_exp_f32 v73, v73
    v_exp_f32 v74, v74
    v_smfmac_f32_32x32x32_bf16 v[96:111], v[156:159], v[64:71], v135
    v_exp_f32 v75, v75
    v_exp_f32 v76, v76
    v_exp_f32 v77, v77
    v_exp_f32 v78, v78
    v_exp_f32 v79, v79
    v_exp_f32 v80, v80
    v_exp_f32 v81, v81
    v_smfmac_f32_32x32x32_bf16 v[96:111], v[160:163], v[72:79], v135
    v_exp_f32 v82, v82
    v_exp_f32 v83, v83
    v_exp_f32 v84, v84
    v_mfma_f32_32x32x16_bf16 v[64:79], v[136:139], v[4:7], v[16:31]
    v_exp_f32 v85, v85
    v_exp_f32 v86, v86
    v_exp_f32 v87, v87
    v_exp_f32 v88, v88
    v_exp_f32 v89, v89
    v_exp_f32 v90, v90
    v_smfmac_f32_32x32x32_bf16 v[112:127], v[156:159], v[80:87], v135
    s_waitcnt lgkmcnt(0)
    v_exp_f32 v91, v91
    v_exp_f32 v92, v92
    v_exp_f32 v93, v93
    v_exp_f32 v94, v94
    v_exp_f32 v95, v95
    v_exp_f32 v64, v64
    v_exp_f32 v65, v65
    v_smfmac_f32_32x32x32_bf16 v[112:127], v[160:163], v[88:95], v135
    ds_read_b128 v[156:159], v13 offset:10400
    ds_read_b128 v[160:163], v145 offset:10400
    v_exp_f32 v66, v66
    v_exp_f32 v67, v67
    v_exp_f32 v68, v68
    v_mfma_f32_32x32x16_bf16 v[80:95], v[136:139], v[8:11], v[32:47]
    ds_read_b128 v[136:139], v12 offset:12480
    v_exp_f32 v69, v69
    v_exp_f32 v70, v70
    v_exp_f32 v71, v71
    v_exp_f32 v72, v72
    v_exp_f32 v73, v73
    v_exp_f32 v74, v74
    v_smfmac_f32_32x32x32_bf16 v[96:111], v[148:151], v[64:71], v135
    v_exp_f32 v75, v75
    v_exp_f32 v76, v76
    v_exp_f32 v77, v77
    v_exp_f32 v78, v78
    v_exp_f32 v79, v79
    v_exp_f32 v80, v80
    v_exp_f32 v81, v81
    v_smfmac_f32_32x32x32_bf16 v[96:111], v[152:155], v[72:79], v135
    v_exp_f32 v82, v82
    v_exp_f32 v83, v83
    v_exp_f32 v84, v84
    v_mfma_f32_32x32x16_bf16 v[64:79], v[140:143], v[4:7], v[16:31]
    v_exp_f32 v85, v85
    v_exp_f32 v86, v86
    v_exp_f32 v87, v87
    v_exp_f32 v88, v88
    v_exp_f32 v89, v89
    v_exp_f32 v90, v90
    v_smfmac_f32_32x32x32_bf16 v[112:127], v[148:151], v[80:87], v135
    s_waitcnt lgkmcnt(0)
    v_exp_f32 v91, v91
    v_exp_f32 v92, v92
    v_exp_f32 v93, v93
    v_exp_f32 v94, v94
    v_exp_f32 v95, v95
    v_exp_f32 v64, v64
    v_exp_f32 v65, v65
    v_smfmac_f32_32x32x32_bf16 v[112:127], v[152:155], v[88:95], v135
    ds_read_b128 v[148:151], v13 offset:12480
    ds_read_b128 v[152:155], v145 offset:12480
    v_exp_f32 v66, v66
    v_exp_f32 v67, v67
    v_exp_f32 v68, v68
    v_mfma_f32_32x32x16_bf16 v[80:95], v[140:143], v[8:11], v[32:47]
    ds_read_b128 v[140:143], v12 offset:14560
    v_exp_f32 v69, v69
    v_exp_f32 v70, v70
    v_exp_f32 v71, v71
    v_exp_f32 v72, v72
    v_exp_f32 v73, v73
    v_exp_f32 v74, v74
    v_smfmac_f32_32x32x32_bf16 v[96:111], v[156:159], v[64:71], v135
    v_exp_f32 v75, v75
    v_exp_f32 v76, v76
    v_exp_f32 v77, v77
    v_exp_f32 v78, v78
    v_exp_f32 v79, v79
    v_exp_f32 v80, v80
    v_exp_f32 v81, v81
    v_smfmac_f32_32x32x32_bf16 v[96:111], v[160:163], v[72:79], v135
    v_exp_f32 v82, v82
    v_exp_f32 v83, v83
    v_exp_f32 v84, v84
    v_mfma_f32_32x32x16_bf16 v[64:79], v[136:139], v[4:7], v[16:31]
    v_exp_f32 v85, v85
    v_exp_f32 v86, v86
    v_exp_f32 v87, v87
    v_exp_f32 v88, v88
    v_exp_f32 v89, v89
    v_exp_f32 v90, v90
    v_smfmac_f32_32x32x32_bf16 v[112:127], v[156:159], v[80:87], v135
    s_waitcnt lgkmcnt(0)
    v_exp_f32 v91, v91
    v_exp_f32 v92, v92
    v_exp_f32 v93, v93
    v_exp_f32 v94, v94
    v_exp_f32 v95, v95
    v_exp_f32 v64, v64
    v_exp_f32 v65, v65
    v_smfmac_f32_32x32x32_bf16 v[112:127], v[160:163], v[88:95], v135
    ds_read_b128 v[156:159], v13 offset:14560
    ds_read_b128 v[160:163], v145 offset:14560
    v_exp_f32 v66, v66
    v_exp_f32 v67, v67
    v_exp_f32 v68, v68
    v_mfma_f32_32x32x16_bf16 v[80:95], v[136:139], v[8:11], v[32:47]
    ds_read_b128 v[136:139], v12 offset:16640
    v_exp_f32 v69, v69
    v_exp_f32 v70, v70
    v_exp_f32 v71, v71
    v_exp_f32 v72, v72
    v_exp_f32 v73, v73
    v_exp_f32 v74, v74
    v_smfmac_f32_32x32x32_bf16 v[96:111], v[148:151], v[64:71], v135
    v_exp_f32 v75, v75
    v_exp_f32 v76, v76
    v_exp_f32 v77, v77
    v_exp_f32 v78, v78
    v_exp_f32 v79, v79
    v_exp_f32 v80, v80
    v_exp_f32 v81, v81
    v_smfmac_f32_32x32x32_bf16 v[96:111], v[152:155], v[72:79], v135
    v_exp_f32 v82, v82
    v_exp_f32 v83, v83
    v_exp_f32 v84, v84
    v_mfma_f32_32x32x16_bf16 v[64:79], v[140:143], v[4:7], v[16:31]
    v_exp_f32 v85, v85
    v_exp_f32 v86, v86
    v_exp_f32 v87, v87
    v_exp_f32 v88, v88
    v_exp_f32 v89, v89
    v_exp_f32 v90, v90
    v_smfmac_f32_32x32x32_bf16 v[112:127], v[148:151], v[80:87], v135
    s_waitcnt lgkmcnt(0)
    v_exp_f32 v91, v91
    v_exp_f32 v92, v92
    v_exp_f32 v93, v93
    v_exp_f32 v94, v94
    v_exp_f32 v95, v95
    v_exp_f32 v64, v64
    v_exp_f32 v65, v65
    v_smfmac_f32_32x32x32_bf16 v[112:127], v[152:155], v[88:95], v135
    ds_read_b128 v[148:151], v13 offset:16640
    ds_read_b128 v[152:155], v145 offset:16640
    v_exp_f32 v66, v66
    v_exp_f32 v67, v67
    v_exp_f32 v68, v68
    v_mfma_f32_32x32x16_bf16 v[80:95], v[140:143], v[8:11], v[32:47]
    ds_read_b128 v[140:143], v12 offset:18720
    v_exp_f32 v69, v69
    v_exp_f32 v70, v70
    v_exp_f32 v71, v71
    v_exp_f32 v72, v72
    v_exp_f32 v73, v73
    v_exp_f32 v74, v74
    v_smfmac_f32_32x32x32_bf16 v[96:111], v[156:159], v[64:71], v135
    v_exp_f32 v75, v75
    v_exp_f32 v76, v76
    v_exp_f32 v77, v77
    v_exp_f32 v78, v78
    v_exp_f32 v79, v79
    v_exp_f32 v80, v80
    v_exp_f32 v81, v81
    v_smfmac_f32_32x32x32_bf16 v[96:111], v[160:163], v[72:79], v135
    s_add_u32 s67, s67, 1
    v_exp_f32 v82, v82
    v_exp_f32 v83, v83
    v_exp_f32 v84, v84
    v_mfma_f32_32x32x16_bf16 v[64:79], v[136:139], v[4:7], v[16:31]
    s_cmp_eq_u32 s67, s68
    v_add_u32 v12, 16640, v12
    v_add_u32 v13, 16640, v13
    v_add_u32 v145, 16640, v145
    v_exp_f32 v85, v85
    v_exp_f32 v86, v86
    v_exp_f32 v87, v87
    v_exp_f32 v88, v88
    v_exp_f32 v89, v89
    v_exp_f32 v90, v90
    v_smfmac_f32_32x32x32_bf16 v[112:127], v[156:159], v[80:87], v135
    s_waitcnt lgkmcnt(0)
    v_exp_f32 v91, v91
    v_exp_f32 v92, v92
    v_exp_f32 v93, v93
    v_exp_f32 v94, v94
    v_exp_f32 v95, v95
    s_cbranch_scc0 .Lloop
    s_cmp_eq_u32 s67, s66
    s_cbranch_scc1 .Ldone
    v_mov_b32 v2, 160304
.Llw5:
    ds_read_b128 v[48:51], v2
    s_waitcnt lgkmcnt(0)
    v_and_b32 v48, v48, v49
    v_and_b32 v50, v50, v51
    v_and_b32 v48, v48, v50
    s_nop 0
    v_readfirstlane_b32 s59, v48
    s_cmp_eq_u32 s59, 1
    s_cbranch_scc1 .Llwok6
    s_sleep 2
    s_branch .Llw5
.Llwok6:
    s_mov_b32 s68, s66
    s_branch .Lloop
.Ldone:
    v_smfmac_f32_32x32x32_bf16 v[112:127], v[160:163], v[88:95], v135
    v_add_u32 v52, s81, v144
    v_lshl_add_u32 v53, v1, 3, s81
    v_mov_b32 v54, s82
    s_cmp_eq_u32 s69, 0
    s_cbranch_scc0 .Lfinal
    v_mov_b32 v2, 160288
.Llw7:
    ds_read_b128 v[16:19], v2
    s_waitcnt lgkmcnt(0)
    v_and_b32 v16, v16, v17
    v_and_b32 v18, v18, v19
    v_and_b32 v16, v16, v18
    s_nop 0
    v_readfirstlane_b32 s59, v16
    s_cmp_eq_u32 s59, 2
    s_cbranch_scc1 .Llwok8
    s_sleep 2
    s_branch .Llw7
.Llwok8:
    v_mov_b32 v105, v120
    ds_write_b128 v52, v[96:99]
    ds_write_b128 v52, v[100:103] offset:1024
    ds_write_b128 v52, v[112:115] offset:2048
    ds_write_b128 v52, v[116:119] offset:3072
    ds_write_b64 v53, v[104:105] offset:4096
    v_mov_b32 v2, 1
    s_waitcnt lgkmcnt(0)
    ds_write_b32 v54, v2
    s_mov_b32 s72, s56
    s_mov_b32 s73, 0
    s_branch .Lph3
.Lfinal:
    s_setprio 3
    v_mov_b32 v55, s85
    v_mov_b32 v56, s90
.Llv9:
    ds_read_b32 v16, v54
    s_waitcnt lgkmcnt(0)
    v_readfirstlane_b32 s59, v16
    s_cmp_lg_u32 s59, 0
    s_cbranch_scc1 .Llvok10
    s_sleep 1
    s_branch .Llv9
.Llvok10:
    ds_read_b128 v[16:19], v52
    ds_read_b128 v[20:23], v52 offset:1024
    ds_read_b64 v[32:33], v53 offset:4096
    ds_read_b128 v[24:27], v52 offset:2048
    ds_read_b128 v[28:31], v52 offset:3072
    v_mov_b32 v3, 0x7b800000
    s_waitcnt lgkmcnt(2)
    v_add_f32 v96, v96, v16
    v_add_f32 v97, v97, v17
    v_add_f32 v98, v98, v18
    v_add_f32 v99, v99, v19
    v_add_f32 v100, v100, v20
    v_add_f32 v101, v101, v21
    v_add_f32 v102, v102, v22
    v_add_f32 v103, v103, v23
    v_add_f32 v104, v104, v32
    v_add_f32 v120, v120, v33
    s_waitcnt lgkmcnt(0)
    v_add_f32 v112, v112, v24
    v_add_f32 v113, v113, v25
    v_add_f32 v114, v114, v26
    v_add_f32 v115, v115, v27
    v_add_f32 v116, v116, v28
    v_add_f32 v117, v117, v29
    v_add_f32 v118, v118, v30
    v_add_f32 v119, v119, v31
    v_max_f32 v2, v104, v120
    v_fmac_f32 v2, 0, v104
    v_fmac_f32 v2, 0, v120
    v_fmac_f32 v2, 0, v96
    v_fmac_f32 v2, 0, v112
    v_fmac_f32 v2, 0, v97
    v_fmac_f32 v2, 0, v113
    v_fmac_f32 v2, 0, v98
    v_fmac_f32 v2, 0, v114
    v_fmac_f32 v2, 0, v99
    v_fmac_f32 v2, 0, v115
    v_fmac_f32 v2, 0, v100
    v_fmac_f32 v2, 0, v116
    v_fmac_f32 v2, 0, v101
    v_fmac_f32 v2, 0, v117
    v_fmac_f32 v2, 0, v102
    v_fmac_f32 v2, 0, v118
    v_fmac_f32 v2, 0, v103
    v_fmac_f32 v2, 0, v119
    v_cmp_nlt_f32 vcc, v2, v3
    v_min_f32 v2, v104, v120
    v_mov_b32 v3, 0x0b800000
    v_cmp_nge_f32 s[62:63], v2, v3
    v_rcp_f32 v2, v104
    v_rcp_f32 v3, v120
    s_nop 1
    s_or_b64 vcc, vcc, s[62:63]
    s_cbranch_scc1 .Lslow
.Lfin:
    v_mul_f32 v96, v2, v96
    v_mul_f32 v97, v2, v97
    v_cvt_pk_bf16_f32 v4, v96, v97
    v_mul_f32 v98, v2, v98
    v_mul_f32 v99, v2, v99
    v_cvt_pk_bf16_f32 v5, v98, v99
    v_mul_f32 v100, v2, v100
    v_mul_f32 v101, v2, v101
    v_cvt_pk_bf16_f32 v6, v100, v101
    v_mul_f32 v102, v2, v102
    v_mul_f32 v103, v2, v103
    v_cvt_pk_bf16_f32 v7, v102, v103
    buffer_store_dwordx4 v[4:7], v144, s[40:43], s80 offen offset:0 sc1
    v_mul_f32 v112, v3, v112
    v_mul_f32 v113, v3, v113
    v_cvt_pk_bf16_f32 v8, v112, v113
    v_mul_f32 v114, v3, v114
    v_mul_f32 v115, v3, v115
    v_cvt_pk_bf16_f32 v9, v114, v115
    v_mul_f32 v116, v3, v116
    v_mul_f32 v117, v3, v117
    v_cvt_pk_bf16_f32 v10, v116, v117
    v_mul_f32 v118, v3, v118
    v_mul_f32 v119, v3, v119
    v_cvt_pk_bf16_f32 v11, v118, v119
    buffer_store_dwordx4 v[8:11], v144, s[40:43], s80 offen offset:1024 sc1
    s_waitcnt vmcnt(0)
    s_mov_b64 exec, 1
    buffer_store_dword v56, v55, s[40:43], 0 offen sc1
    s_mov_b64 exec, -1
    s_endpgm
.Lph3:
    s_setprio 0
    s_and_b32 s74, s58, 7
    s_lshr_b32 s75, s58, 3
    s_mul_i32 s76, s74, 288
    s_lshl_b32 s59, s72, 3
    s_add_u32 s76, s76, s59
    s_add_u32 s76, s76, 112
    s_lshl_b32 s76, s76, 10
    s_add_u32 s76, s76, 6553600
    s_lshl_b32 s77, s57, 2
    s_lshl_b32 s60, s75, 1
    s_add_u32 s77, s77, s60
    s_add_u32 s77, s77, s73
    s_lshl_b32 s78, s77, 5
    s_add_u32 s78, s78, s59
    s_lshl_b32 s78, s78, 10
    s_add_u32 s78, s78, 2359296
    s_lshl_b32 s79, s77, 15
    s_lshl_b32 s60, s74, 7
    s_add_u32 s79, s79, s60
    s_lshr_b32 s60, s72, 1
    s_lshl_b32 s60, s60, 6
    s_add_u32 s79, s79, s60
    s_and_b32 s60, s72, 1
    s_lshl_b32 s60, s60, 4
    s_add_u32 s79, s79, s60
    s_add_u32 s81, s76, 147456
    s_add_u32 s82, s76, 4096
    s_add_u32 s83, s81, 4096
    s_add_u32 s84, s78, 4096
    v_and_b32 v2, 31, v1
    v_lshrrev_b32 v3, 5, v1
    v_lshlrev_b32 v57, 10, v2
    v_lshl_add_u32 v57, v3, 5, v57
    s_lshl_b32 s59, s73, 2
    s_add_u32 s59, s59, s72
    s_lshl_b32 s59, s59, 10
    s_add_u32 s59, s59, 151552
    v_add_u32 v2, s59, v144
    ds_read_b128 v[48:51], v2
    buffer_load_dwordx4 v[64:67], v144, s[40:43], s76 offen offset:0 sc1
    buffer_load_dwordx4 v[68:71], v144, s[40:43], s81 offen offset:0 sc1
    buffer_load_dwordx4 v[72:75], v144, s[40:43], s76 offen offset:1024 sc1
    buffer_load_dwordx4 v[76:79], v144, s[40:43], s81 offen offset:1024 sc1
    buffer_load_dwordx4 v[80:83], v144, s[40:43], s76 offen offset:2048 sc1
    buffer_load_dwordx4 v[84:87], v144, s[40:43], s81 offen offset:2048 sc1
    buffer_load_dwordx4 v[88:91], v144, s[40:43], s76 offen offset:3072 sc1
    buffer_load_dwordx4 v[92:95], v144, s[40:43], s81 offen offset:3072 sc1
    buffer_load_dwordx4 v[96:99], v144, s[40:43], s82 offen offset:0 sc1
    buffer_load_dwordx4 v[100:103], v144, s[40:43], s83 offen offset:0 sc1
    buffer_load_dwordx4 v[104:107], v144, s[40:43], s82 offen offset:1024 sc1
    buffer_load_dwordx4 v[108:111], v144, s[40:43], s83 offen offset:1024 sc1
    buffer_load_dwordx4 v[112:115], v144, s[40:43], s82 offen offset:2048 sc1
    buffer_load_dwordx4 v[116:119], v144, s[40:43], s83 offen offset:2048 sc1
    buffer_load_dwordx4 v[120:123], v144, s[40:43], s82 offen offset:3072 sc1
    buffer_load_dwordx4 v[124:127], v144, s[40:43], s83 offen offset:3072 sc1
    buffer_load_dwordx4 v[12:15], v57, s[28:31], s79 offen
    s_mov_b32 s44, s22
    s_mov_b32 s45, s23
    s_mov_b32 s46, 2097152
    s_mov_b32 s47, 0x00020000
    v_and_b32 v2, 3, v1
    v_lshlrev_b32 v2, 9, v2
    s_lshl_b32 s61, s57, 4
    s_lshl_b32 s60, s72, 2
    s_add_u32 s61, s61, s60
    s_lshl_b32 s61, s61, 9
    s_and_b32 s60, s77, 3
    s_lshl_b32 s60, s60, 7
    s_add_u32 s61, s61, s60
    s_add_u32 s61, s61, 1179648
    s_lshl_b32 s59, s73, 15
    s_lshl_b32 s60, s72, 11
    s_add_u32 s64, s60, s59
    s_lshl_b32 s60, s72, 13
    s_add_u32 s65, s60, s59
    s_mov_b32 s60, 0
    s_mov_b32 s62, 0
    s_mov_b32 s63, 0
    s_waitcnt vmcnt(0) lgkmcnt(0)
    s_barrier
    buffer_load_dword v3, v2, s[40:43], s61 offen sc1
    v_lshlrev_b32 v32, 16, v48
    v_and_b32 v33, s86, v48
    v_lshlrev_b32 v34, 16, v49
    v_and_b32 v35, s86, v49
    v_lshlrev_b32 v36, 16, v50
    v_and_b32 v37, s86, v50
    v_lshlrev_b32 v38, 16, v51
    v_and_b32 v39, s86, v51
    v_mul_f32 v40, 0xbfb8aa3b, v32
    v_mul_f32 v41, 0xbfb8aa3b, v33
    v_mul_f32 v42, 0xbfb8aa3b, v34
    v_mul_f32 v43, 0xbfb8aa3b, v35
    v_mul_f32 v44, 0xbfb8aa3b, v36
    v_mul_f32 v45, 0xbfb8aa3b, v37
    v_mul_f32 v46, 0xbfb8aa3b, v38
    v_mul_f32 v47, 0xbfb8aa3b, v39
    v_exp_f32 v40, v40
    v_exp_f32 v41, v41
    v_exp_f32 v42, v42
    v_exp_f32 v43, v43
    v_exp_f32 v44, v44
    v_exp_f32 v45, v45
    v_exp_f32 v46, v46
    v_exp_f32 v47, v47
    v_add_f32 v40, 1.0, v40
    v_add_f32 v41, 1.0, v41
    v_add_f32 v42, 1.0, v42
    v_add_f32 v43, 1.0, v43
    v_add_f32 v44, 1.0, v44
    v_add_f32 v45, 1.0, v45
    v_add_f32 v46, 1.0, v46
    v_add_f32 v47, 1.0, v47
    v_rcp_f32 v40, v40
    v_rcp_f32 v41, v41
    v_rcp_f32 v42, v42
    v_rcp_f32 v43, v43
    v_rcp_f32 v44, v44
    v_rcp_f32 v45, v45
    v_rcp_f32 v46, v46
    v_rcp_f32 v47, v47
    v_mul_f32 v32, v32, v40
    v_mul_f32 v33, v33, v41
    v_cvt_pk_bf16_f32 v48, v32, v33
    v_mul_f32 v34, v34, v42
    v_mul_f32 v35, v35, v43
    v_cvt_pk_bf16_f32 v49, v34, v35
    v_mul_f32 v36, v36, v44
    v_mul_f32 v37, v37, v45
    v_cvt_pk_bf16_f32 v50, v36, v37
    v_mul_f32 v38, v38, v46
    v_mul_f32 v39, v39, v47
    v_cvt_pk_bf16_f32 v51, v38, v39
    v_lshlrev_b32 v58, 16, v48
    v_and_b32 v59, s86, v48
    v_lshlrev_b32 v60, 16, v49
    v_and_b32 v61, s86, v49
    v_lshlrev_b32 v62, 16, v50
    v_and_b32 v63, s86, v50
    v_lshlrev_b32 v52, 16, v51
    v_and_b32 v53, s86, v51
    v_mov_b32 v48, 0
    v_mov_b32 v49, 0
    v_add_u32 v54, s64, v144
    v_add_u32 v55, s65, v144
    v_mfma_f32_32x32x8_bf16 v[16:31], v[48:49], v[48:49], 0
    v_mfma_f32_32x32x8_bf16 v[32:47], v[48:49], v[48:49], 0
    v_lshlrev_b32 v4, 16, v12
    v_and_b32 v5, s86, v12
    v_lshlrev_b32 v6, 16, v13
    v_and_b32 v7, s86, v13
    v_lshlrev_b32 v8, 16, v14
    v_and_b32 v9, s86, v14
    v_lshlrev_b32 v10, 16, v15
    v_and_b32 v11, s86, v15
    s_branch .Lpo1
.Lpo:
    s_sleep 2
    buffer_load_dword v3, v2, s[40:43], s61 offen sc1
.Lpo1:
    s_add_u32 s60, s60, 1
    s_waitcnt vmcnt(0)
    v_cmp_eq_u32 vcc, s90, v3
    s_add_u32 s64, s62, 1
    s_xor_b32 s64, s64, s62
    s_lshr_b32 s59, s64, 1
    s_andn2_b32 s64, s59, s63
    s_mov_b32 s63, s59
    s_cmp_lt_u32 s60, 0x40000
    s_cselect_b32 s65, 0, 15
    s_or_b32 s65, s65, vcc_lo
    s_and_b32 s65, s65, 15
    s_andn2_b32 s65, s65, s62
    s_or_b32 s62, s62, s65
    s_bitcmp1_b32 s65, 0
    s_cbranch_scc0 .Lld11
    buffer_load_dwordx4 v[128:131], v144, s[40:43], s78 offen offset:0 sc1
    buffer_load_dwordx4 v[132:135], v144, s[40:43], s78 offen offset:1024 sc1
.Lld11:
    s_bitcmp1_b32 s65, 1
    s_cbranch_scc0 .Lld12
    buffer_load_dwordx4 v[136:139], v144, s[40:43], s78 offen offset:2048 sc1
    buffer_load_dwordx4 v[140:143], v144, s[40:43], s78 offen offset:3072 sc1
.Lld12:
    s_bitcmp1_b32 s65, 2
    s_cbranch_scc0 .Lld13
    buffer_load_dwordx4 v[148:151], v144, s[40:43], s84 offen offset:0 sc1
    buffer_load_dwordx4 v[152:155], v144, s[40:43], s84 offen offset:1024 sc1
.Lld13:
    s_bitcmp1_b32 s65, 3
    s_cbranch_scc0 .Lld14
    buffer_load_dwordx4 v[156:159], v144, s[40:43], s84 offen offset:2048 sc1
    buffer_load_dwordx4 v[160:163], v144, s[40:43], s84 offen offset:3072 sc1
.Lld14:
    s_bitcmp1_b32 s64, 0
    s_cbranch_scc0 .Lmm15
    v_mfma_f32_32x32x16_bf16 v[16:31], v[64:67], v[128:131], v[16:31]
    v_mfma_f32_32x32x16_bf16 v[32:47], v[68:71], v[128:131], v[32:47]
    v_mfma_f32_32x32x16_bf16 v[16:31], v[72:75], v[132:135], v[16:31]
    v_mfma_f32_32x32x16_bf16 v[32:47], v[76:79], v[132:135], v[32:47]
.Lmm15:
    s_bitcmp1_b32 s64, 1
    s_cbranch_scc0 .Lmm16
    v_mfma_f32_32x32x16_bf16 v[16:31], v[80:83], v[136:139], v[16:31]
    v_mfma_f32_32x32x16_bf16 v[32:47], v[84:87], v[136:139], v[32:47]
    v_mfma_f32_32x32x16_bf16 v[16:31], v[88:91], v[140:143], v[16:31]
    v_mfma_f32_32x32x16_bf16 v[32:47], v[92:95], v[140:143], v[32:47]
.Lmm16:
    s_bitcmp1_b32 s64, 2
    s_cbranch_scc0 .Lmm17
    v_mfma_f32_32x32x16_bf16 v[16:31], v[96:99], v[148:151], v[16:31]
    v_mfma_f32_32x32x16_bf16 v[32:47], v[100:103], v[148:151], v[32:47]
    v_mfma_f32_32x32x16_bf16 v[16:31], v[104:107], v[152:155], v[16:31]
    v_mfma_f32_32x32x16_bf16 v[32:47], v[108:111], v[152:155], v[32:47]
.Lmm17:
    s_bitcmp1_b32 s64, 3
    s_cbranch_scc0 .Lmm18
    v_mfma_f32_32x32x16_bf16 v[16:31], v[112:115], v[156:159], v[16:31]
    v_mfma_f32_32x32x16_bf16 v[32:47], v[116:119], v[156:159], v[32:47]
    v_mfma_f32_32x32x16_bf16 v[16:31], v[120:123], v[160:163], v[16:31]
    v_mfma_f32_32x32x16_bf16 v[32:47], v[124:127], v[160:163], v[32:47]
.Lmm18:
    s_cmp_eq_u32 s62, 15
    s_cbranch_scc0 .Lpo
    s_andn2_b32 s65, 15, s63
    s_waitcnt vmcnt(0)
    s_bitcmp1_b32 s65, 0
    s_cbranch_scc0 .Lmm19
    v_mfma_f32_32x32x16_bf16 v[16:31], v[64:67], v[128:131], v[16:31]
    v_mfma_f32_32x32x16_bf16 v[32:47], v[68:71], v[128:131], v[32:47]
    v_mfma_f32_32x32x16_bf16 v[16:31], v[72:75], v[132:135], v[16:31]
    v_mfma_f32_32x32x16_bf16 v[32:47], v[76:79], v[132:135], v[32:47]
.Lmm19:
    s_bitcmp1_b32 s65, 1
    s_cbranch_scc0 .Lmm20
    v_mfma_f32_32x32x16_bf16 v[16:31], v[80:83], v[136:139], v[16:31]
    v_mfma_f32_32x32x16_bf16 v[32:47], v[84:87], v[136:139], v[32:47]
    v_mfma_f32_32x32x16_bf16 v[16:31], v[88:91], v[140:143], v[16:31]
    v_mfma_f32_32x32x16_bf16 v[32:47], v[92:95], v[140:143], v[32:47]
.Lmm20:
    s_bitcmp1_b32 s65, 2
    s_cbranch_scc0 .Lmm21
    v_mfma_f32_32x32x16_bf16 v[16:31], v[96:99], v[148:151], v[16:31]
    v_mfma_f32_32x32x16_bf16 v[32:47], v[100:103], v[148:151], v[32:47]
    v_mfma_f32_32x32x16_bf16 v[16:31], v[104:107], v[152:155], v[16:31]
    v_mfma_f32_32x32x16_bf16 v[32:47], v[108:111], v[152:155], v[32:47]
.Lmm21:
    s_bitcmp1_b32 s65, 3
    s_cbranch_scc0 .Lmm22
    v_mfma_f32_32x32x16_bf16 v[16:31], v[112:115], v[156:159], v[16:31]
    v_mfma_f32_32x32x16_bf16 v[32:47], v[116:119], v[156:159], v[32:47]
    v_mfma_f32_32x32x16_bf16 v[16:31], v[120:123], v[160:163], v[16:31]
    v_mfma_f32_32x32x16_bf16 v[32:47], v[124:127], v[160:163], v[32:47]
.Lmm22:
    s_nop 10
    ds_write_b128 v54, v[16:19] offset:0
    ds_write_b128 v54, v[20:23] offset:1024
    ds_write_b128 v54, v[24:27] offset:8192
    ds_write_b128 v54, v[28:31] offset:9216
    ds_write_b128 v54, v[32:35] offset:16384
    ds_write_b128 v54, v[36:39] offset:17408
    ds_write_b128 v54, v[40:43] offset:24576
    ds_write_b128 v54, v[44:47] offset:25600
    s_waitcnt lgkmcnt(0)
    s_barrier
    ds_read_b128 v[16:19], v55 offset:0
    ds_read_b128 v[20:23], v55 offset:1024
    ds_read_b128 v[24:27], v55 offset:2048
    ds_read_b128 v[28:31], v55 offset:3072
    ds_read_b128 v[32:35], v55 offset:4096
    ds_read_b128 v[36:39], v55 offset:5120
    ds_read_b128 v[40:43], v55 offset:6144
    ds_read_b128 v[44:47], v55 offset:7168
    s_waitcnt lgkmcnt(4)
    v_add_f32 v16, v16, v24
    v_add_f32 v17, v17, v25
    v_add_f32 v18, v18, v26
    v_add_f32 v19, v19, v27
    v_add_f32 v20, v20, v28
    v_add_f32 v21, v21, v29
    v_add_f32 v22, v22, v30
    v_add_f32 v23, v23, v31
    s_waitcnt lgkmcnt(0)
    v_add_f32 v32, v32, v40
    v_add_f32 v33, v33, v41
    v_add_f32 v34, v34, v42
    v_add_f32 v35, v35, v43
    v_add_f32 v36, v36, v44
    v_add_f32 v37, v37, v45
    v_add_f32 v38, v38, v46
    v_add_f32 v39, v39, v47
    v_add_f32 v16, v16, v32
    v_add_f32 v17, v17, v33
    v_fmac_f32 v4, v16, v58
    v_fmac_f32 v5, v17, v59
    v_cvt_pk_bf16_f32 v48, v4, v5
    v_add_f32 v18, v18, v34
    v_add_f32 v19, v19, v35
    v_fmac_f32 v6, v18, v60
    v_fmac_f32 v7, v19, v61
    v_cvt_pk_bf16_f32 v49, v6, v7
    v_add_f32 v20, v20, v36
    v_add_f32 v21, v21, v37
    v_fmac_f32 v8, v20, v62
    v_fmac_f32 v9, v21, v63
    v_cvt_pk_bf16_f32 v50, v8, v9
    v_add_f32 v22, v22, v38
    v_add_f32 v23, v23, v39
    v_fmac_f32 v10, v22, v52
    v_fmac_f32 v11, v23, v53
    v_cvt_pk_bf16_f32 v51, v10, v11
    buffer_store_dwordx4 v[48:51], v57, s[44:47], s79 offen
    s_endpgm
.Lslow:
    v_mov_b32 v12, v144
    v_mov_b32 v2, 0xff800000
    v_mov_b32 v3, 0xff800000
    s_mov_b32 s67, 0
.Lsmax:
    ds_read_b128 v[136:139], v12
    v_add_u32 v12, 2080, v12
    s_waitcnt lgkmcnt(0)
    v_mfma_f32_32x32x16_bf16 v[64:79], v[136:139], v[4:7], 0
    v_mfma_f32_32x32x16_bf16 v[80:95], v[136:139], v[8:11], 0
    s_add_u32 s67, s67, 1
    s_nop 10
    v_max3_f32 v2, v64, v65, v2
    v_max3_f32 v2, v66, v67, v2
    v_max3_f32 v2, v68, v69, v2
    v_max3_f32 v2, v70, v71, v2
    v_max3_f32 v2, v72, v73, v2
    v_max3_f32 v2, v74, v75, v2
    v_max3_f32 v2, v76, v77, v2
    v_max3_f32 v2, v78, v79, v2
    v_max3_f32 v3, v80, v81, v3
    v_max3_f32 v3, v82, v83, v3
    v_max3_f32 v3, v84, v85, v3
    v_max3_f32 v3, v86, v87, v3
    v_max3_f32 v3, v88, v89, v3
    v_max3_f32 v3, v90, v91, v3
    v_max3_f32 v3, v92, v93, v3
    v_max3_f32 v3, v94, v95, v3
    s_cmp_lt_u32 s67, 64
    s_cbranch_scc1 .Lsmax
    v_mov_b32 v12, v2
    v_mov_b32 v13, v3
    s_nop 1
    v_permlane32_swap_b32 v2, v12
    v_permlane32_swap_b32 v3, v13
    v_max_f32 v2, v2, v12
    v_max_f32 v3, v3, v13
    v_sub_f32 v16, 0, v2
    v_mov_b32 v96, 0
    v_sub_f32 v17, 0, v2
    v_mov_b32 v97, 0
    v_sub_f32 v18, 0, v2
    v_mov_b32 v98, 0
    v_sub_f32 v19, 0, v2
    v_mov_b32 v99, 0
    v_sub_f32 v20, 0, v2
    v_mov_b32 v100, 0
    v_sub_f32 v21, 0, v2
    v_mov_b32 v101, 0
    v_sub_f32 v22, 0, v2
    v_mov_b32 v102, 0
    v_sub_f32 v23, 0, v2
    v_mov_b32 v103, 0
    v_sub_f32 v24, 0, v2
    v_mov_b32 v104, 0
    v_sub_f32 v25, 0, v2
    v_mov_b32 v105, 0
    v_sub_f32 v26, 0, v2
    v_mov_b32 v106, 0
    v_sub_f32 v27, 0, v2
    v_mov_b32 v107, 0
    v_sub_f32 v28, 0, v2
    v_mov_b32 v108, 0
    v_sub_f32 v29, 0, v2
    v_mov_b32 v109, 0
    v_sub_f32 v30, 0, v2
    v_mov_b32 v110, 0
    v_sub_f32 v31, 0, v2
    v_mov_b32 v111, 0
    v_sub_f32 v32, 0, v3
    v_mov_b32 v112, 0
    v_sub_f32 v33, 0, v3
    v_mov_b32 v113, 0
    v_sub_f32 v34, 0, v3
    v_mov_b32 v114, 0
    v_sub_f32 v35, 0, v3
    v_mov_b32 v115, 0
    v_sub_f32 v36, 0, v3
    v_mov_b32 v116, 0
    v_sub_f32 v37, 0, v3
    v_mov_b32 v117, 0
    v_sub_f32 v38, 0, v3
    v_mov_b32 v118, 0
    v_sub_f32 v39, 0, v3
    v_mov_b32 v119, 0
    v_sub_f32 v40, 0, v3
    v_mov_b32 v120, 0
    v_sub_f32 v41, 0, v3
    v_mov_b32 v121, 0
    v_sub_f32 v42, 0, v3
    v_mov_b32 v122, 0
    v_sub_f32 v43, 0, v3
    v_mov_b32 v123, 0
    v_sub_f32 v44, 0, v3
    v_mov_b32 v124, 0
    v_sub_f32 v45, 0, v3
    v_mov_b32 v125, 0
    v_sub_f32 v46, 0, v3
    v_mov_b32 v126, 0
    v_sub_f32 v47, 0, v3
    v_mov_b32 v127, 0
    v_mov_b32 v12, v144
    s_mov_b32 s67, 0
.Lsacc:
    ds_read_b128 v[136:139], v12
    ds_read_b128 v[148:151], v14
    ds_read_b128 v[152:155], v15
    v_add_u32 v12, 2080, v12
    v_add_u32 v14, 2080, v14
    v_add_u32 v15, 2080, v15
    s_waitcnt lgkmcnt(0)
    v_mfma_f32_32x32x16_bf16 v[64:79], v[136:139], v[4:7], v[16:31]
    v_mfma_f32_32x32x16_bf16 v[80:95], v[136:139], v[8:11], v[32:47]
    s_add_u32 s67, s67, 1
    s_nop 10
    v_exp_f32 v64, v64
    v_exp_f32 v65, v65
    v_exp_f32 v66, v66
    v_exp_f32 v67, v67
    v_exp_f32 v68, v68
    v_exp_f32 v69, v69
    v_exp_f32 v70, v70
    v_exp_f32 v71, v71
    v_exp_f32 v72, v72
    v_exp_f32 v73, v73
    v_exp_f32 v74, v74
    v_exp_f32 v75, v75
    v_exp_f32 v76, v76
    v_exp_f32 v77, v77
    v_exp_f32 v78, v78
    v_exp_f32 v79, v79
    s_nop 1
    v_smfmac_f32_32x32x32_bf16 v[96:111], v[148:151], v[64:71], v135
    v_smfmac_f32_32x32x32_bf16 v[96:111], v[152:155], v[72:79], v135
    v_exp_f32 v80, v80
    v_exp_f32 v81, v81
    v_exp_f32 v82, v82
    v_exp_f32 v83, v83
    v_exp_f32 v84, v84
    v_exp_f32 v85, v85
    v_exp_f32 v86, v86
    v_exp_f32 v87, v87
    v_exp_f32 v88, v88
    v_exp_f32 v89, v89
    v_exp_f32 v90, v90
    v_exp_f32 v91, v91
    v_exp_f32 v92, v92
    v_exp_f32 v93, v93
    v_exp_f32 v94, v94
    v_exp_f32 v95, v95
    s_nop 1
    v_smfmac_f32_32x32x32_bf16 v[112:127], v[148:151], v[80:87], v135
    v_smfmac_f32_32x32x32_bf16 v[112:127], v[152:155], v[88:95], v135
    s_cmp_lt_u32 s67, 64
    s_cbranch_scc1 .Lsacc
    s_nop 15
    v_rcp_f32 v2, v104
    v_rcp_f32 v3, v120
    s_nop 0
    s_branch .Lfin
.Laux:
    s_setprio 3
    s_sub_u32 s72, s56, 8
    s_lshr_b32 s73, s58, 1
    s_and_b32 s74, s58, 1
    v_and_b32 v7, 15, v1
    v_lshrrev_b32 v8, 4, v1
    v_lshlrev_b32 v9, 10, v7
    v_lshl_add_u32 v9, v8, 4, v9
    s_lshl_b32 s75, s57, 3
    s_add_u32 s75, s75, s73
    s_lshl_b32 s76, s75, 14
    s_lshl_b32 s59, s72, 8
    s_add_u32 s76, s76, s59
    s_lshl_b32 s60, s72, 12
    s_add_u32 m0, s60, 32768
    s_mov_b32 s46, 16384
    s_mov_b32 s47, 0x00020000
    s_waitcnt lgkmcnt(0)
    s_cmp_eq_u32 s74, 0
    s_cselect_b32 s44, s8, s10
    s_cselect_b32 s45, s9, s11
    s_mov_b32 s28, s4
    s_mov_b32 s29, s5
    s_mov_b32 s63, s60
    buffer_load_dwordx4 v144, s[44:47], s60 offen offset:0 lds
    buffer_load_dwordx4 v144, s[44:47], s60 offen offset:1024 lds
    buffer_load_dwordx4 v144, s[44:47], s60 offen offset:2048 lds
    buffer_load_dwordx4 v144, s[44:47], s60 offen offset:3072 lds
    buffer_load_dwordx4 v[16:19], v9, s[28:31], s76 offen offset:0
    buffer_load_dwordx4 v[20:23], v9, s[28:31], s76 offen offset:64
    buffer_load_dwordx4 v[24:27], v9, s[28:31], s76 offen offset:128
    buffer_load_dwordx4 v[28:31], v9, s[28:31], s76 offen offset:192
    s_mov_b32 s40, s26
    s_mov_b32 s41, s27
    s_add_u32 s92, s26, 2031616
    s_addc_u32 s93, s27, 0
    s_load_dword s90, s[92:93], 0
    v_lshlrev_b32 v2, 2, v1
    v_add_u32 v2, 160256, v2
    v_mov_b32 v3, 0
    ds_write_b32 v2, v3
    v_and_b32 v6, 1, v1
    v_lshlrev_b32 v6, 1, v6
    v_bfe_u32 v10, v1, 1, 1
    v_or_b32 v6, v6, v10
    v_bfe_u32 v10, v1, 2, 2
    v_lshl_add_u32 v10, v8, 3, v10
    v_lshlrev_b32 v10, 5, v10
    v_lshl_add_u32 v10, v6, 3, v10
    s_add_u32 s60, s60, 32768
    v_add_u32 v10, s60, v10
    v_mov_b32 v12, 0x3f803f80
    v_mov_b32 v13, 0x3f803f80
    v_mov_b32 v14, 0x3f803f80
    v_mov_b32 v15, 0x3f803f80
    s_barrier
    s_waitcnt vmcnt(4)
    ds_read_b64_tr_b16 v[32:33], v10 offset:0
    ds_read_b64_tr_b16 v[34:35], v10 offset:128
    ds_read_b64_tr_b16 v[36:37], v10 offset:1024
    ds_read_b64_tr_b16 v[38:39], v10 offset:1152
    ds_read_b64_tr_b16 v[40:41], v10 offset:2048
    ds_read_b64_tr_b16 v[42:43], v10 offset:2176
    ds_read_b64_tr_b16 v[44:45], v10 offset:3072
    ds_read_b64_tr_b16 v[46:47], v10 offset:3200
    v_and_b32 v2, 3, v1
    v_cmp_eq_u32 s[62:63], 1, v2
    v_cmp_eq_u32 s[64:65], 2, v2
    v_cmp_eq_u32 s[66:67], 3, v2
    s_mul_i32 s59, s72, 1792
    s_add_u32 s59, s59, 151552
    v_add_u32 v3, s59, v144
    v_lshl_add_u32 v4, v1, 2, s59
    s_waitcnt vmcnt(0)
    v_mfma_f32_16x16x32_bf16 v[60:63], v[16:19], v[16:19], 0
    v_mfma_f32_16x16x32_bf16 v[56:59], v[12:15], v[16:19], 0
    v_mfma_f32_16x16x32_bf16 v[60:63], v[20:23], v[20:23], v[60:63]
    v_mfma_f32_16x16x32_bf16 v[56:59], v[12:15], v[20:23], v[56:59]
    v_mfma_f32_16x16x32_bf16 v[60:63], v[24:27], v[24:27], v[60:63]
    v_mfma_f32_16x16x32_bf16 v[56:59], v[12:15], v[24:27], v[56:59]
    v_mfma_f32_16x16x32_bf16 v[60:63], v[28:31], v[28:31], v[60:63]
    v_mfma_f32_16x16x32_bf16 v[56:59], v[12:15], v[28:31], v[56:59]
    s_waitcnt lgkmcnt(0)
    s_mul_i32 s90, s90, 0x9e3779b1
    s_add_u32 s90, s90, 0x7f4a7c15
    v_mfma_f32_16x16x32_bf16 v[52:55], v[12:15], v[32:35], 0
    v_mfma_f32_16x16x32_bf16 v[48:51], v[32:35], v[16:19], 0
    v_mfma_f32_16x16x32_bf16 v[52:55], v[12:15], v[36:39], v[52:55]
    v_mfma_f32_16x16x32_bf16 v[48:51], v[36:39], v[20:23], v[48:51]
    v_mfma_f32_16x16x32_bf16 v[52:55], v[12:15], v[40:43], v[52:55]
    v_mfma_f32_16x16x32_bf16 v[48:51], v[40:43], v[24:27], v[48:51]
    v_mfma_f32_16x16x32_bf16 v[52:55], v[12:15], v[44:47], v[52:55]
    v_mfma_f32_16x16x32_bf16 v[48:51], v[44:47], v[28:31], v[48:51]
    v_cndmask_b32 v5, v60, v61, s[62:63]
    v_cndmask_b32 v5, v5, v62, s[64:65]
    v_cndmask_b32 v5, v5, v63, s[66:67]
    ds_write_b32 v4, v5 offset:1024
    ds_write_b32 v4, v56 offset:1280
    s_nop 2
    ds_write_b32 v4, v52 offset:1536
    ds_write_b128 v3, v[48:51]
    s_waitcnt lgkmcnt(0)
    s_barrier
    s_cmp_eq_u32 s72, 0
    s_cbranch_scc0 .Ltrans
    v_lshrrev_b32 v2, 2, v7
    v_lshl_add_u32 v2, v2, 4, v7
    v_lshlrev_b32 v2, 2, v2
    v_add_u32 v2, 151552, v2
    ds_read_b32 v16, v2 offset:1024
    ds_read_b32 v17, v2 offset:2816
    ds_read_b32 v18, v2 offset:4608
    ds_read_b32 v19, v2 offset:6400
    ds_read_b32 v21, v4 offset:3072
    ds_read_b32 v25, v4 offset:3328
    ds_read_b128 v[32:35], v3 offset:1792
    ds_read_b32 v22, v4 offset:4864
    ds_read_b32 v26, v4 offset:5120
    ds_read_b128 v[36:39], v3 offset:3584
    ds_read_b32 v23, v4 offset:6656
    ds_read_b32 v27, v4 offset:6912
    ds_read_b128 v[40:43], v3 offset:5376
    s_lshr_b32 s59, s75, 1
    s_lshl_b32 s59, s59, 11
    s_add_u32 s77, s59, 2097152
    s_and_b32 s78, s75, 1
    s_lshl_b32 s79, s75, 7
    s_add_u32 s79, s79, 2293760
    s_waitcnt lgkmcnt(0)
    v_add_f32 v56, v56, v21
    v_add_f32 v22, v22, v23
    v_add_f32 v52, v52, v25
    v_add_f32 v26, v26, v27
    v_add_f32 v56, v56, v22
    v_add_f32 v52, v52, v26
    v_add_f32 v16, v16, v17
    v_add_f32 v18, v18, v19
    v_add_f32 v5, v16, v18
    v_add_f32 v48, v48, v32
    v_add_f32 v36, v36, v40
    v_add_f32 v48, v48, v36
    v_add_f32 v49, v49, v33
    v_add_f32 v37, v37, v41
    v_add_f32 v49, v49, v37
    v_add_f32 v50, v50, v34
    v_add_f32 v38, v38, v42
    v_add_f32 v50, v50, v38
    v_add_f32 v51, v51, v35
    v_add_f32 v39, v39, v43
    v_add_f32 v51, v51, v39
    s_barrier
    v_mul_f32 v56, 0x3b000000, v56
    v_cvt_pk_bf16_f32 v128, -v56, -v56
    v_cvt_pk_bf16_f32 v2, v52, v52
    v_and_b32 v2, s86, v2
    v_sub_f32 v2, v52, v2
    v_cvt_pk_bf16_f32 v132, v52, v2
    v_and_b32 v3, s86, v132
    v_sub_f32 v2, v2, v3
    v_cvt_pk_bf16_f32 v133, v2, 0
    v_cmp_gt_u32 vcc, 16, v1
    v_and_b32 v131, 0xffff, v128
    v_mul_f32 v5, 0x3b000000, v5
    v_cndmask_b32 v130, 0, v128, vcc
    v_cndmask_b32 v131, 0, v131, vcc
    v_fma_f32 v5, -v56, v56, v5
    v_max_f32 v5, 0, v5
    v_mfma_f32_16x16x16_bf16 v[48:51], v[132:133], v[130:131], v[48:51]
    v_cvt_pk_bf16_f32 v5, v5, v5
    v_and_b32 v5, s86, v5
    v_add_f32 v5, 0x3727c5ac, v5
    v_cvt_pk_bf16_f32 v5, v5, v5
    v_and_b32 v5, s86, v5
    v_sqrt_f32 v5, v5
    s_nop 0
    v_cvt_pk_bf16_f32 v5, v5, v5
    v_and_b32 v5, s86, v5
    v_rcp_f32 v129, v5
    v_lshlrev_b32 v2, 3, v1
    v_mul_f32 v48, v129, v48
    v_mul_f32 v49, v129, v49
    v_mul_f32 v50, v129, v50
    v_mul_f32 v51, v129, v51
    v_cvt_pk_bf16_f32 v136, v48, v49
    v_cvt_pk_bf16_f32 v137, v50, v51
    v_lshrrev_b32 v5, 4, v1
    v_lshlrev_b32 v5, 8, v5
    v_add_u32 v5, v5, v144
    v_add_u32 v5, 148480, v5
    s_lshl_b32 s62, s58, 4
    s_add_u32 s63, s62, s57
    s_lshl_b32 s63, s63, 10
    s_add_u32 s63, s63, 1310720
    s_lshl_b32 s62, s62, 10
    s_add_u32 s62, s62, 1310720
    s_cmp_eq_u32 s74, 0
    s_cbranch_scc0 .Lvjob
    v_mov_b32 v138, v136
    v_mov_b32 v139, v137
    v_lshlrev_b32 v3, 9, v8
    v_permlane32_swap_b32 v136, v138
    v_permlane32_swap_b32 v137, v139
    v_lshl_add_u32 v3, v7, 4, v3
    s_lshl_b32 s78, s78, 8
    s_add_u32 s77, s77, s78
    s_mov_b32 s64, 0xffff
    s_branch .Lkvdone
.Lvjob:
    v_lshrrev_b32 v3, 3, v7
    v_lshlrev_b32 v3, 8, v3
    v_lshl_add_u32 v3, v8, 6, v3
    v_and_b32 v4, 7, v7
    v_lshl_add_u32 v3, v4, 1, v3
    v_add_u32 v3, 159744, v3
    ds_write_b16 v3, v136
    ds_write_b16_d16_hi v3, v136 offset:16
    ds_write_b16 v3, v137 offset:32
    ds_write_b16_d16_hi v3, v137 offset:48
    v_add_u32 v4, 159744, v144
    s_lshl_b32 s78, s78, 9
    s_add_u32 s77, s77, s78
    s_add_u32 s77, s77, 1024
    s_waitcnt lgkmcnt(0)
    s_mov_b64 exec, 0xffffffff
    ds_read_b128 v[136:139], v4
    s_mov_b64 exec, -1
    v_mov_b32 v3, v144
    s_mov_b32 s64, 0
    s_waitcnt lgkmcnt(0)
.Lkvdone:
    ds_read_b128 v[16:19], v5
    ds_read_b128 v[20:23], v5 offset:256
    s_mov_b64 exec, 0xffffffff
    buffer_store_dwordx4 v[136:139], v3, s[40:43], s77 offen sc1
    s_mov_b64 exec, -1
    s_waitcnt lgkmcnt(0)
    v_add_f32 v16, v16, v20
    v_add_f32 v17, v17, v21
    v_add_f32 v18, v18, v22
    v_add_f32 v19, v19, v23
    buffer_store_dwordx4 v[16:19], v144, s[40:43], s63 offen sc1
    s_cmp_eq_u32 s64, 0
    s_cbranch_scc1 .Lnostat
    s_mov_b64 exec, 0xffff
    buffer_store_dwordx2 v[128:129], v2, s[40:43], s79 offen sc1
    s_mov_b64 exec, -1
.Lnostat:
    s_barrier
    s_waitcnt vmcnt(0)
    s_lshl_b32 s59, s57, 7
    s_lshl_b32 s60, s58, 2
    s_add_u32 s59, s59, s60
    s_lshl_b32 s60, s58, 7
    s_lshl_b32 s61, s57, 2
    s_add_u32 s60, s60, s61
    s_add_u32 s60, s60, 1056768
    v_lshlrev_b32 v2, 12, v1
    v_add_u32 v2, 1048576, v2
    v_add_u32 v2, s59, v2
    v_mov_b32 v3, s90
    v_writelane_b32 v2, s60, 2
    s_mov_b64 exec, 7
    buffer_store_dword v3, v2, s[40:43], 0 offen sc1
    s_mov_b64 exec, -1
    s_barrier
    s_barrier
    v_and_b32 v2, 15, v1
    v_lshlrev_b32 v2, 2, v2
    s_lshl_b32 s59, s57, 7
    s_add_u32 s59, s59, 1052672
    s_lshl_b32 s60, s58, 7
    s_add_u32 s60, s60, 1056768
    v_and_b32 v3, 16, v1
    v_cmp_eq_u32 vcc, 0, v3
    v_mov_b32 v3, s59
    v_mov_b32 v4, s60
    v_cndmask_b32 v3, v4, v3, vcc
    v_add_u32 v2, v2, v3
    s_mov_b32 s60, 0
.Lpg0:
    buffer_load_dword v3, v2, s[40:43], 0 offen sc1
.Lpg1:
    s_add_u32 s60, s60, 1
    s_waitcnt vmcnt(0)
    v_cmp_ne_u32 vcc, s90, v3
    s_nop 3
    s_cmp_eq_u64 vcc, 0
    s_cbranch_scc1 .Lpg2
    s_cmp_lt_u32 s60, 0x40000
    s_cbranch_scc0 .Lpg2
    s_sleep 4
    s_branch .Lpg0
.Lpg2:
    s_barrier
    s_lshl_b32 s63, s57, 10
    s_add_u32 s63, s63, 2293760
    buffer_load_dwordx4 v[8:11], v144, s[40:43], s63 offen sc1
    v_add_u32 v2, 150528, v144
    buffer_load_dwordx4 v[16:19], v144, s[40:43], s62 offen offset:0 sc1
    buffer_load_dwordx4 v[20:23], v144, s[40:43], s62 offen offset:1024 sc1
    buffer_load_dwordx4 v[24:27], v144, s[40:43], s62 offen offset:2048 sc1
    buffer_load_dwordx4 v[28:31], v144, s[40:43], s62 offen offset:3072 sc1
    s_add_u32 s62, s62, 4096
    buffer_load_dwordx4 v[32:35], v144, s[40:43], s62 offen offset:0 sc1
    buffer_load_dwordx4 v[36:39], v144, s[40:43], s62 offen offset:1024 sc1
    buffer_load_dwordx4 v[40:43], v144, s[40:43], s62 offen offset:2048 sc1
    buffer_load_dwordx4 v[44:47], v144, s[40:43], s62 offen offset:3072 sc1
    s_add_u32 s62, s62, 4096
    buffer_load_dwordx4 v[48:51], v144, s[40:43], s62 offen offset:0 sc1
    buffer_load_dwordx4 v[52:55], v144, s[40:43], s62 offen offset:1024 sc1
    buffer_load_dwordx4 v[56:59], v144, s[40:43], s62 offen offset:2048 sc1
    buffer_load_dwordx4 v[60:63], v144, s[40:43], s62 offen offset:3072 sc1
    s_add_u32 s62, s62, 4096
    buffer_load_dwordx4 v[64:67], v144, s[40:43], s62 offen offset:0 sc1
    buffer_load_dwordx4 v[68:71], v144, s[40:43], s62 offen offset:1024 sc1
    buffer_load_dwordx4 v[72:75], v144, s[40:43], s62 offen offset:2048 sc1
    buffer_load_dwordx4 v[76:79], v144, s[40:43], s62 offen offset:3072 sc1
    s_add_u32 s62, s62, 4096
    s_barrier
    v_lshlrev_b32 v3, 5, v1
    v_add_u32 v3, 148480, v3
    s_waitcnt vmcnt(0)
    ds_write_b128 v2, v[8:11]
    v_add_f32 v16, v16, v48
    v_add_f32 v17, v17, v49
    v_add_f32 v18, v18, v50
    v_add_f32 v19, v19, v51
    v_add_f32 v20, v20, v52
    v_add_f32 v21, v21, v53
    v_add_f32 v22, v22, v54
    v_add_f32 v23, v23, v55
    v_add_f32 v24, v24, v56
    v_add_f32 v25, v25, v57
    v_add_f32 v26, v26, v58
    v_add_f32 v27, v27, v59
    v_add_f32 v28, v28, v60
    v_add_f32 v29, v29, v61
    v_add_f32 v30, v30, v62
    v_add_f32 v31, v31, v63
    v_add_f32 v32, v32, v64
    v_add_f32 v33, v33, v65
    v_add_f32 v34, v34, v66
    v_add_f32 v35, v35, v67
    v_add_f32 v36, v36, v68
    v_add_f32 v37, v37, v69
    v_add_f32 v38, v38, v70
    v_add_f32 v39, v39, v71
    v_add_f32 v40, v40, v72
    v_add_f32 v41, v41, v73
    v_add_f32 v42, v42, v74
    v_add_f32 v43, v43, v75
    v_add_f32 v44, v44, v76
    v_add_f32 v45, v45, v77
    v_add_f32 v46, v46, v78
    v_add_f32 v47, v47, v79
    v_add_f32 v16, v16, v32
    v_add_f32 v17, v17, v33
    v_add_f32 v18, v18, v34
    v_add_f32 v19, v19, v35
    v_add_f32 v20, v20, v36
    v_add_f32 v21, v21, v37
    v_add_f32 v22, v22, v38
    v_add_f32 v23, v23, v39
    v_add_f32 v24, v24, v40
    v_add_f32 v25, v25, v41
    v_add_f32 v26, v26, v42
    v_add_f32 v27, v27, v43
    v_add_f32 v28, v28, v44
    v_add_f32 v29, v29, v45
    v_add_f32 v30, v30, v46
    v_add_f32 v31, v31, v47
    v_add_f32 v16, v16, v24
    v_add_f32 v17, v17, v25
    v_add_f32 v18, v18, v26
    v_add_f32 v19, v19, v27
    v_add_f32 v20, v20, v28
    v_add_f32 v21, v21, v29
    v_add_f32 v22, v22, v30
    v_add_f32 v23, v23, v31
    v_add_f32 v16, v16, v20
    v_add_f32 v17, v17, v21
    v_add_f32 v18, v18, v22
    v_add_f32 v19, v19, v23
    v_cvt_pk_bf16_f32 v4, v16, v16
    v_and_b32 v4, s86, v4
    v_sub_f32 v4, v16, v4
    v_cvt_pk_bf16_f32 v24, v16, v4
    v_and_b32 v5, s86, v24
    v_sub_f32 v4, v4, v5
    v_cvt_pk_bf16_f32 v25, v4, 0
    v_cvt_pk_bf16_f32 v4, v17, v17
    v_and_b32 v4, s86, v4
    v_sub_f32 v4, v17, v4
    v_cvt_pk_bf16_f32 v26, v17, v4
    v_and_b32 v5, s86, v26
    v_sub_f32 v4, v4, v5
    v_cvt_pk_bf16_f32 v27, v4, 0
    v_cvt_pk_bf16_f32 v4, v18, v18
    v_and_b32 v4, s86, v4
    v_sub_f32 v4, v18, v4
    v_cvt_pk_bf16_f32 v28, v18, v4
    v_and_b32 v5, s86, v28
    v_sub_f32 v4, v4, v5
    v_cvt_pk_bf16_f32 v29, v4, 0
    v_cvt_pk_bf16_f32 v4, v19, v19
    v_and_b32 v4, s86, v4
    v_sub_f32 v4, v19, v4
    v_cvt_pk_bf16_f32 v30, v19, v4
    v_and_b32 v5, s86, v30
    v_sub_f32 v4, v4, v5
    v_cvt_pk_bf16_f32 v31, v4, 0
    ds_write_b128 v3, v[24:27]
    ds_write_b128 v3, v[28:31] offset:16
    s_waitcnt lgkmcnt(0)
    s_branch .Lauxj
.Ltrans:
    s_barrier
    s_barrier
    s_barrier
    s_barrier
    s_barrier
    s_barrier
    s_cmp_eq_u32 s72, 1
    s_cbranch_scc0 .Lnoseed
    v_lshrrev_b32 v2, 2, v1
    v_and_b32 v8, 3, v1
    v_lshlrev_b32 v2, 7, v2
    v_lshl_add_u32 v2, v8, 4, v2
    s_mov_b32 s61, 1048576
    s_mov_b32 s60, 0
.Lpoll23:
    buffer_load_dwordx4 v[8:11], v2, s[40:43], s61 offen sc1
.Lpollm25:
    s_add_u32 s60, s60, 1
    s_waitcnt vmcnt(0)
    v_xor_b32 v8, s90, v8
    v_xor_b32 v9, s90, v9
    v_xor_b32 v10, s90, v10
    v_xor_b32 v11, s90, v11
    v_or3_b32 v8, v8, v9, v10
    v_or_b32 v8, v8, v11
    v_cmp_ne_u32 vcc, 0, v8
    s_nop 3
    s_cmp_eq_u64 vcc, 0
    s_cbranch_scc1 .Lpollok24
    s_cmp_lt_u32 s60, 0x40000
    s_cbranch_scc0 .Lpollok24
    s_sleep 4
    s_branch .Lpoll23
.Lpollok24:
    s_cmp_eq_u32 s2, 0
    s_cbranch_scc0 .Lnoseed
    v_mov_b32 v4, 2031616
    v_mov_b32 v3, s90
    s_mov_b64 exec, 1
    buffer_store_dword v3, v4, s[40:43], 0 offen sc1
    s_mov_b64 exec, -1
.Lnoseed:
.Lauxj:
    s_barrier
    s_lshl_b32 s84, s72, 3
    s_lshr_b32 s59, s58, 3
    s_lshl_b32 s59, s59, 1
    s_lshr_b32 s60, s72, 1
    s_add_u32 s59, s59, s60
    s_lshl_b32 s59, s59, 8
    s_add_u32 s59, s59, 150532
    v_and_b32 v2, 31, v1
    v_lshl_add_u32 v2, v2, 3, s59
    ds_read_b32 v147, v2
    s_lshr_b32 s59, 0x23222120, s84
    s_and_b32 s59, s59, 255
    s_lshl_b32 s61, s59, 10
    s_lshr_b32 s59, s59, 1
    s_lshl_b32 s59, s59, 5
    s_add_u32 m0, s61, s59
    s_add_u32 s61, s61, 2097152
    buffer_load_dwordx4 v144, s[40:43], s61 offen sc1 lds
    s_lshr_b32 s59, 0x27262524, s84
    s_and_b32 s59, s59, 255
    s_lshl_b32 s61, s59, 10
    s_lshr_b32 s59, s59, 1
    s_lshl_b32 s59, s59, 5
    s_add_u32 m0, s61, s59
    s_add_u32 s61, s61, 2097152
    buffer_load_dwordx4 v144, s[40:43], s61 offen sc1 lds
    s_lshr_b32 s59, 0x2b2a2928, s84
    s_and_b32 s59, s59, 255
    s_lshl_b32 s61, s59, 10
    s_lshr_b32 s59, s59, 1
    s_lshl_b32 s59, s59, 5
    s_add_u32 m0, s61, s59
    s_add_u32 s61, s61, 2097152
    buffer_load_dwordx4 v144, s[40:43], s61 offen sc1 lds
    s_lshr_b32 s59, 0x2f2e2d2c, s84
    s_and_b32 s59, s59, 255
    s_lshl_b32 s61, s59, 10
    s_lshr_b32 s59, s59, 1
    s_lshl_b32 s59, s59, 5
    s_add_u32 m0, s61, s59
    s_add_u32 s61, s61, 2097152
    buffer_load_dwordx4 v144, s[40:43], s61 offen sc1 lds
    s_lshr_b32 s59, 0x33323130, s84
    s_and_b32 s59, s59, 255
    s_lshl_b32 s61, s59, 10
    s_lshr_b32 s59, s59, 1
    s_lshl_b32 s59, s59, 5
    s_add_u32 m0, s61, s59
    s_add_u32 s61, s61, 2097152
    buffer_load_dwordx4 v144, s[40:43], s61 offen sc1 lds
    s_waitcnt lgkmcnt(0)
    v_mul_f32 v147, v147, v147
    s_lshl_b32 s59, s72, 6
    v_add_u32 v2, s59, v1
    v_lshrrev_b32 v3, 1, v2
    v_and_b32 v4, 1, v2
    v_mul_u32_u24 v3, 2080, v3
    v_lshl_add_u32 v3, v4, 4, v3
    v_add_u32 v3, 2048, v3
    v_cmp_eq_u32 vcc, 0, v4
    v_mov_b32 v5, 0x3f803f80
    s_nop 0
    v_cndmask_b32 v4, 0, v5, vcc
    v_mov_b32 v5, v4
    v_mov_b32 v6, v4
    v_mov_b32 v7, v4
    s_mov_b32 s60, 16384
    v_subrev_u32 v8, 16384, v3
    v_cmp_gt_u32 vcc, s60, v8
    s_nop 3
    s_mov_b64 s[62:63], vcc
    s_mov_b32 s60, 28928
    v_subrev_u32 v8, 78080, v3
    v_cmp_gt_u32 vcc, s60, v8
    s_nop 3
    s_or_b64 s[62:63], s[62:63], vcc
    s_cmp_lt_u32 s72, 2
    s_cbranch_scc0 .Lno1a
    s_andn2_b64 exec, exec, s[62:63]
    ds_write_b128 v3, v[4:7]
    s_mov_b64 exec, -1
.Lno1a:
    s_lshr_b32 s59, 0x37363534, s84
    s_and_b32 s59, s59, 255
    s_lshl_b32 s61, s59, 10
    s_lshr_b32 s59, s59, 1
    s_lshl_b32 s59, s59, 5
    s_add_u32 m0, s61, s59
    s_add_u32 s61, s61, 2097152
    buffer_load_dwordx4 v144, s[40:43], s61 offen sc1 lds
    s_lshr_b32 s59, 0x3b3a3938, s84
    s_and_b32 s59, s59, 255
    s_lshl_b32 s61, s59, 10
    s_lshr_b32 s59, s59, 1
    s_lshl_b32 s59, s59, 5
    s_add_u32 m0, s61, s59
    s_add_u32 s61, s61, 2097152
    buffer_load_dwordx4 v144, s[40:43], s61 offen sc1 lds
    s_lshr_b32 s59, 0x3f3e3d3c, s84
    s_and_b32 s59, s59, 255
    s_lshl_b32 s61, s59, 10
    s_lshr_b32 s59, s59, 1
    s_lshl_b32 s59, s59, 5
    s_add_u32 m0, s61, s59
    s_add_u32 s61, s61, 2097152
    buffer_load_dwordx4 v144, s[40:43], s61 offen sc1 lds
    s_lshr_b32 s59, 0x43424140, s84
    s_and_b32 s59, s59, 255
    s_lshl_b32 s61, s59, 10
    s_lshr_b32 s59, s59, 1
    s_lshl_b32 s59, s59, 5
    s_add_u32 m0, s61, s59
    s_add_u32 s61, s61, 2097152
    buffer_load_dwordx4 v144, s[40:43], s61 offen sc1 lds
    s_lshr_b32 s59, 0x47464544, s84
    s_and_b32 s59, s59, 255
    s_lshl_b32 s61, s59, 10
    s_lshr_b32 s59, s59, 1
    s_lshl_b32 s59, s59, 5
    s_add_u32 m0, s61, s59
    s_add_u32 s61, s61, 2097152
    buffer_load_dwordx4 v144, s[40:43], s61 offen sc1 lds
    s_lshr_b32 s59, 0x674a4948, s84
    s_and_b32 s59, s59, 255
    s_lshl_b32 s61, s59, 10
    s_lshr_b32 s59, s59, 1
    s_lshl_b32 s59, s59, 5
    s_add_u32 m0, s61, s59
    s_add_u32 s61, s61, 2097152
    buffer_load_dwordx4 v144, s[40:43], s61 offen sc1 lds
    s_lshr_b32 s59, 0x6b6a6968, s84
    s_and_b32 s59, s59, 255
    s_lshl_b32 s61, s59, 10
    s_lshr_b32 s59, s59, 1
    s_lshl_b32 s59, s59, 5
    s_add_u32 m0, s61, s59
    s_add_u32 s61, s61, 2097152
    buffer_load_dwordx4 v144, s[40:43], s61 offen sc1 lds
    s_lshr_b32 s59, 0x6f6e6d6c, s84
    s_and_b32 s59, s59, 255
    s_lshl_b32 s61, s59, 10
    s_lshr_b32 s59, s59, 1
    s_lshl_b32 s59, s59, 5
    s_add_u32 m0, s61, s59
    s_add_u32 s61, s61, 2097152
    buffer_load_dwordx4 v144, s[40:43], s61 offen sc1 lds
    s_lshr_b32 s59, 0x73727170, s84
    s_and_b32 s59, s59, 255
    s_lshl_b32 s61, s59, 10
    s_lshr_b32 s59, s59, 1
    s_lshl_b32 s59, s59, 5
    s_add_u32 m0, s61, s59
    s_add_u32 s61, s61, 2097152
    buffer_load_dwordx4 v144, s[40:43], s61 offen sc1 lds
    s_lshr_b32 s59, 0x77767574, s84
    s_and_b32 s59, s59, 255
    s_lshl_b32 s61, s59, 10
    s_lshr_b32 s59, s59, 1
    s_lshl_b32 s59, s59, 5
    s_add_u32 m0, s61, s59
    s_add_u32 s61, s61, 2097152
    buffer_load_dwordx4 v144, s[40:43], s61 offen sc1 lds
    s_lshr_b32 s59, 0x7b7a7978, s84
    s_and_b32 s59, s59, 255
    s_lshl_b32 s61, s59, 10
    s_lshr_b32 s59, s59, 1
    s_lshl_b32 s59, s59, 5
    s_add_u32 m0, s61, s59
    s_add_u32 s61, s61, 2097152
    buffer_load_dwordx4 v144, s[40:43], s61 offen sc1 lds
    s_lshr_b32 s59, 0x7f7e7d7c, s84
    s_and_b32 s59, s59, 255
    s_lshl_b32 s61, s59, 10
    s_lshr_b32 s59, s59, 1
    s_lshl_b32 s59, s59, 5
    s_add_u32 m0, s61, s59
    s_add_u32 s61, s61, 2097152
    buffer_load_dwordx4 v144, s[40:43], s61 offen sc1 lds
    s_lshr_b32 s59, 0x3020100, s84
    s_and_b32 s59, s59, 255
    s_lshl_b32 s61, s59, 10
    s_lshr_b32 s59, s59, 1
    s_lshl_b32 s59, s59, 5
    s_add_u32 m0, s61, s59
    s_add_u32 s61, s61, 2097152
    buffer_load_dwordx4 v144, s[40:43], s61 offen sc1 lds
    s_lshr_b32 s59, 0x7060504, s84
    s_and_b32 s59, s59, 255
    s_lshl_b32 s61, s59, 10
    s_lshr_b32 s59, s59, 1
    s_lshl_b32 s59, s59, 5
    s_add_u32 m0, s61, s59
    s_add_u32 s61, s61, 2097152
    buffer_load_dwordx4 v144, s[40:43], s61 offen sc1 lds
    s_lshr_b32 s59, 0xb0a0908, s84
    s_and_b32 s59, s59, 255
    s_lshl_b32 s61, s59, 10
    s_lshr_b32 s59, s59, 1
    s_lshl_b32 s59, s59, 5
    s_add_u32 m0, s61, s59
    s_add_u32 s61, s61, 2097152
    buffer_load_dwordx4 v144, s[40:43], s61 offen sc1 lds
    s_lshr_b32 s59, 0xe0e0d0c, s84
    s_and_b32 s59, s59, 255
    s_lshl_b32 s61, s59, 10
    s_lshr_b32 s59, s59, 1
    s_lshl_b32 s59, s59, 5
    s_add_u32 m0, s61, s59
    s_add_u32 s61, s61, 2097152
    buffer_load_dwordx4 v144, s[40:43], s61 offen sc1 lds
    v_lshrrev_b32 v9, 2, v1
    v_and_b32 v10, 3, v1
    v_lshlrev_b32 v62, 10, v9
    v_lshl_add_u32 v62, v10, 4, v62
    v_lshrrev_b32 v10, 5, v1
    v_and_b32 v9, 3, v9
    v_lshl_add_u32 v9, v10, 3, v9
    v_lshlrev_b32 v63, 6, v9
    v_and_b32 v10, 1, v1
    v_lshl_add_u32 v63, v10, 5, v63
    v_bfe_u32 v10, v1, 4, 1
    v_lshl_add_u32 v63, v10, 4, v63
    v_bfe_u32 v10, v1, 1, 1
    v_lshl_add_u32 v63, v10, 3, v63
    s_lshl_b32 s73, s57, 1
    s_lshr_b32 s59, s58, 3
    s_add_u32 s73, s73, s59
    s_mul_i32 s73, s73, 9
    s_mul_i32 s59, s72, 3
    s_add_u32 s73, s73, s59
    s_sub_u32 s73, s73, 3
    s_lshl_b32 s79, s59, 10
    s_add_u32 s79, s79, 130048
    s_cmp_eq_u32 s72, 3
    s_cselect_b32 s79, 144128, s79
    v_add_u32 v63, s79, v63
    s_and_b32 s74, s58, 7
    s_lshl_b32 s74, s74, 1
    s_waitcnt vmcnt(16) lgkmcnt(0)
    s_barrier
    s_setprio 3
    s_lshr_b32 s59, 0x1211100f, s84
    s_and_b32 s59, s59, 255
    s_lshl_b32 s61, s59, 10
    s_lshr_b32 s59, s59, 1
    s_lshl_b32 s59, s59, 5
    s_add_u32 m0, s61, s59
    s_add_u32 s61, s61, 2097152
    buffer_load_dwordx4 v144, s[40:43], s61 offen sc1 lds
    s_lshr_b32 s59, 0x16151413, s84
    s_and_b32 s59, s59, 255
    s_lshl_b32 s61, s59, 10
    s_lshr_b32 s59, s59, 1
    s_lshl_b32 s59, s59, 5
    s_add_u32 m0, s61, s59
    s_add_u32 s61, s61, 2097152
    buffer_load_dwordx4 v144, s[40:43], s61 offen sc1 lds
    s_lshr_b32 s59, 0x1a191817, s84
    s_and_b32 s59, s59, 255
    s_lshl_b32 s61, s59, 10
    s_lshr_b32 s59, s59, 1
    s_lshl_b32 s59, s59, 5
    s_add_u32 m0, s61, s59
    s_add_u32 s61, s61, 2097152
    buffer_load_dwordx4 v144, s[40:43], s61 offen sc1 lds
    s_lshr_b32 s59, 0x1e1d1c1b, s84
    s_and_b32 s59, s59, 255
    s_lshl_b32 s61, s59, 10
    s_lshr_b32 s59, s59, 1
    s_lshl_b32 s59, s59, 5
    s_add_u32 m0, s61, s59
    s_add_u32 s61, s61, 2097152
    buffer_load_dwordx4 v144, s[40:43], s61 offen sc1 lds
    s_lshr_b32 s59, 0x4d4c4b1f, s84
    s_and_b32 s59, s59, 255
    s_lshl_b32 s61, s59, 10
    s_lshr_b32 s59, s59, 1
    s_lshl_b32 s59, s59, 5
    s_add_u32 m0, s61, s59
    s_add_u32 s61, s61, 2097152
    buffer_load_dwordx4 v144, s[40:43], s61 offen sc1 lds
    s_lshr_b32 s59, 0x51504f4e, s84
    s_and_b32 s59, s59, 255
    s_lshl_b32 s61, s59, 10
    s_lshr_b32 s59, s59, 1
    s_lshl_b32 s59, s59, 5
    s_add_u32 m0, s61, s59
    s_add_u32 s61, s61, 2097152
    buffer_load_dwordx4 v144, s[40:43], s61 offen sc1 lds
    s_lshr_b32 s59, 0x55545352, s84
    s_and_b32 s59, s59, 255
    s_lshl_b32 s61, s59, 10
    s_lshr_b32 s59, s59, 1
    s_lshl_b32 s59, s59, 5
    s_add_u32 m0, s61, s59
    s_add_u32 s61, s61, 2097152
    buffer_load_dwordx4 v144, s[40:43], s61 offen sc1 lds
    s_lshr_b32 s59, 0x59585756, s84
    s_and_b32 s59, s59, 255
    s_lshl_b32 s61, s59, 10
    s_lshr_b32 s59, s59, 1
    s_lshl_b32 s59, s59, 5
    s_add_u32 m0, s61, s59
    s_add_u32 s61, s61, 2097152
    buffer_load_dwordx4 v144, s[40:43], s61 offen sc1 lds
    s_lshr_b32 s59, 0x5d5c5b5a, s84
    s_and_b32 s59, s59, 255
    s_lshl_b32 s61, s59, 10
    s_lshr_b32 s59, s59, 1
    s_lshl_b32 s59, s59, 5
    s_add_u32 m0, s61, s59
    s_add_u32 s61, s61, 2097152
    buffer_load_dwordx4 v144, s[40:43], s61 offen sc1 lds
    s_lshr_b32 s59, 0x61605f5e, s84
    s_and_b32 s59, s59, 255
    s_lshl_b32 s61, s59, 10
    s_lshr_b32 s59, s59, 1
    s_lshl_b32 s59, s59, 5
    s_add_u32 m0, s61, s59
    s_add_u32 s61, s61, 2097152
    buffer_load_dwordx4 v144, s[40:43], s61 offen sc1 lds
    s_lshr_b32 s59, 0x65646362, s84
    s_and_b32 s59, s59, 255
    s_lshl_b32 s61, s59, 10
    s_lshr_b32 s59, s59, 1
    s_lshl_b32 s59, s59, 5
    s_add_u32 m0, s61, s59
    s_add_u32 s61, s61, 2097152
    buffer_load_dwordx4 v144, s[40:43], s61 offen sc1 lds
    s_lshr_b32 s59, 0x66666666, s84
    s_and_b32 s59, s59, 255
    s_lshl_b32 s61, s59, 10
    s_lshr_b32 s59, s59, 1
    s_lshl_b32 s59, s59, 5
    s_add_u32 m0, s61, s59
    s_add_u32 s61, s61, 2097152
    buffer_load_dwordx4 v144, s[40:43], s61 offen sc1 lds
    s_cmp_lt_u32 s72, 2
    s_cbranch_scc0 .Lno1b
    s_mov_b64 exec, s[62:63]
    ds_write_b128 v3, v[4:7]
    s_mov_b64 exec, -1
.Lno1b:
    s_lshl_b32 s59, s72, 2
    s_add_u32 s59, s59, 160256
    v_mov_b32 v145, s59
    v_mov_b32 v4, 1
    s_cmp_eq_u32 s72, 0
    s_cbranch_scc0 .Lt1a
    s_waitcnt vmcnt(0)
    s_branch .Lnot1
.Lt1a:
    s_add_u32 s59, s73, 0
    s_lshr_b32 s75, s59, 1
    s_and_b32 s76, s59, 1
    s_add_u32 s76, s76, s74
    s_mov_b32 s46, 524288
    s_cmp_lt_u32 s75, 112
    s_cselect_b32 s44, s20, s12
    s_cselect_b32 s45, s21, s13
    s_cselect_b32 s46, 1835008, s46
    s_cselect_b32 s59, 0, 112
    s_sub_u32 s59, s75, s59
    s_lshl_b32 s77, s59, 14
    s_lshl_b32 s59, s76, 6
    s_add_u32 s77, s77, s59
    s_add_u32 m0, s79, 0
    s_mul_i32 s64, s76, 144
    s_add_u32 s64, s64, s75
    s_lshl_b32 s64, s64, 10
    s_add_u32 s64, s64, 6553600
    buffer_load_dwordx4 v62, s[44:47], s77 offen lds
    s_add_u32 s59, s73, 1
    s_lshr_b32 s75, s59, 1
    s_and_b32 s76, s59, 1
    s_add_u32 s76, s76, s74
    s_mov_b32 s46, 524288
    s_cmp_lt_u32 s75, 112
    s_cselect_b32 s44, s20, s12
    s_cselect_b32 s45, s21, s13
    s_cselect_b32 s46, 1835008, s46
    s_cselect_b32 s59, 0, 112
    s_sub_u32 s59, s75, s59
    s_lshl_b32 s77, s59, 14
    s_lshl_b32 s59, s76, 6
    s_add_u32 s77, s77, s59
    s_add_u32 m0, s79, 1024
    s_mul_i32 s65, s76, 144
    s_add_u32 s65, s65, s75
    s_lshl_b32 s65, s65, 10
    s_add_u32 s65, s65, 6553600
    buffer_load_dwordx4 v62, s[44:47], s77 offen lds
    s_add_u32 s59, s73, 2
    s_lshr_b32 s75, s59, 1
    s_and_b32 s76, s59, 1
    s_add_u32 s76, s76, s74
    s_mov_b32 s46, 524288
    s_cmp_lt_u32 s75, 112
    s_cselect_b32 s44, s20, s12
    s_cselect_b32 s45, s21, s13
    s_cselect_b32 s46, 1835008, s46
    s_cselect_b32 s59, 0, 112
    s_sub_u32 s59, s75, s59
    s_lshl_b32 s77, s59, 14
    s_lshl_b32 s59, s76, 6
    s_add_u32 s77, s77, s59
    s_add_u32 m0, s79, 2048
    s_mul_i32 s66, s76, 144
    s_add_u32 s66, s66, s75
    s_lshl_b32 s66, s66, 10
    s_add_u32 s66, s66, 6553600
    buffer_load_dwordx4 v62, s[44:47], s77 offen lds
    s_waitcnt vmcnt(3)
.Lnot1:
    s_waitcnt lgkmcnt(0)
    ds_write_b32 v145, v4 offset:48
    s_lshr_b32 s73, s72, 1
    s_and_b32 s74, s72, 1
    s_and_b32 s75, s58, 7
    s_lshr_b32 s76, s58, 3
    s_lshl_b32 s59, s57, 2
    s_lshl_b32 s60, s76, 1
    s_add_u32 s59, s59, s60
    s_mul_i32 s59, s59, 112
    s_mul_i32 s60, s72, 28
    s_add_u32 s59, s59, s60
    s_lshl_b32 s59, s59, 10
    s_add_u32 s59, s59, 8912896
    s_mul_i32 s61, s73, 114688
    s_add_u32 s80, s59, s61
    s_sub_u32 s61, 114688, s61
    s_add_u32 s81, s59, s61
    s_mul_i32 s59, s75, 288
    s_add_u32 s59, s59, s60
    s_lshl_b32 s59, s59, 10
    s_add_u32 s59, s59, 6553600
    s_mul_i32 s61, s74, 147456
    s_add_u32 s82, s59, s61
    s_sub_u32 s61, 147456, s61
    s_add_u32 s83, s59, s61
    s_cmp_eq_u32 s72, 0
    s_cbranch_scc0 .Lnosig
    s_lshl_b32 s59, s57, 4
    s_add_u32 s59, s59, s58
    s_lshl_b32 s59, s59, 7
    s_add_u32 s59, s59, 1114112
    v_mov_b32 v8, s59
    s_lshl_b32 s60, s75, 7
    s_add_u32 s60, s60, 1081344
    s_lshl_b32 s59, s57, 1
    s_add_u32 s59, s59, s76
    s_lshl_b32 s59, s59, 2
    s_add_u32 s59, s59, s60
    v_writelane_b32 v8, s59, 1
    v_mov_b32 v9, s90
    v_and_b32 v10, 15, v1
    v_lshlrev_b32 v10, 7, v10
    s_lshl_b32 s59, s57, 11
    s_add_u32 s59, s59, 1114112
    v_add_u32 v10, s59, v10
    v_and_b32 v11, 31, v1
    v_lshl_add_u32 v11, v11, 2, s60
    v_cmp_gt_u32 vcc, 32, v1
    v_mov_b32 v2, 160324
    s_mov_b32 s60, 0
    v_cndmask_b32 v10, v11, v10, vcc
.Lwh:
    ds_read_b32 v3, v2
    s_waitcnt lgkmcnt(0)
    v_readfirstlane_b32 s59, v3
    s_cmp_eq_u32 s59, 11
    s_cbranch_scc1 .Lwhok
    s_sleep 1
    s_branch .Lwh
.Lwhok:
    s_mov_b64 exec, 3
    buffer_store_dword v9, v8, s[40:43], 0 offen sc1
    s_mov_b64 exec, -1
    s_waitcnt vmcnt(0)
.Lph0:
    buffer_load_dword v3, v10, s[40:43], 0 offen sc1
    s_add_u32 s60, s60, 1
    s_waitcnt vmcnt(0)
    v_cmp_ne_u32 vcc, s90, v3
    s_nop 3
    s_cmp_eq_u64 vcc, 0
    s_cbranch_scc1 .Lph1
    s_cmp_lt_u32 s60, 0x40000
    s_cbranch_scc0 .Lph1
    s_sleep 8
    s_branch .Lph0
.Lph1:
    v_mov_b32 v2, 160332
    v_mov_b32 v3, 1
    ds_write_b32 v2, v3
    s_branch .Lhok
.Lnosig:
    s_waitcnt vmcnt(0)
    ds_read_b64_tr_b16 v[48:49], v63 offset:0
    ds_read_b64_tr_b16 v[50:51], v63 offset:256
    ds_read_b64_tr_b16 v[52:53], v63 offset:1024
    ds_read_b64_tr_b16 v[54:55], v63 offset:1280
    ds_read_b64_tr_b16 v[56:57], v63 offset:2048
    ds_read_b64_tr_b16 v[58:59], v63 offset:2304
    v_mov_b32 v2, 160324
    v_mov_b32 v3, 1
    s_waitcnt lgkmcnt(0)
    buffer_store_dwordx4 v[48:51], v144, s[40:43], s64 offen sc1
    buffer_store_dwordx4 v[52:55], v144, s[40:43], s65 offen sc1
    buffer_store_dwordx4 v[56:59], v144, s[40:43], s66 offen sc1
    s_waitcnt vmcnt(0)
    s_mov_b64 exec, 1
    ds_add_u32 v2, v3
    s_mov_b64 exec, -1
    v_mov_b32 v2, 160332
.Llv26:
    ds_read_b32 v3, v2
    s_waitcnt lgkmcnt(0)
    v_readfirstlane_b32 s59, v3
    s_cmp_lg_u32 s59, 0
    s_cbranch_scc1 .Llvok27
    s_sleep 4
    s_branch .Llv26
.Llvok27:
.Lhok:
    buffer_load_dwordx4 v[68:71], v144, s[40:43], s80 offen offset:0 sc1
    buffer_load_dwordx4 v[72:75], v144, s[40:43], s82 offen offset:0 sc1
    buffer_load_dwordx4 v[76:79], v144, s[40:43], s81 offen offset:0 sc1
    buffer_load_dwordx4 v[80:83], v144, s[40:43], s83 offen offset:0 sc1
    buffer_load_dwordx4 v[84:87], v144, s[40:43], s80 offen offset:1024 sc1
    buffer_load_dwordx4 v[88:91], v144, s[40:43], s82 offen offset:1024 sc1
    buffer_load_dwordx4 v[92:95], v144, s[40:43], s81 offen offset:1024 sc1
    buffer_load_dwordx4 v[96:99], v144, s[40:43], s83 offen offset:1024 sc1
    buffer_load_dwordx4 v[100:103], v144, s[40:43], s80 offen offset:2048 sc1
    buffer_load_dwordx4 v[104:107], v144, s[40:43], s82 offen offset:2048 sc1
    buffer_load_dwordx4 v[108:111], v144, s[40:43], s81 offen offset:2048 sc1
    buffer_load_dwordx4 v[112:115], v144, s[40:43], s83 offen offset:2048 sc1
    buffer_load_dwordx4 v[116:119], v144, s[40:43], s80 offen offset:3072 sc1
    s_add_u32 s80, s80, 4096
    buffer_load_dwordx4 v[120:123], v144, s[40:43], s82 offen offset:3072 sc1
    s_add_u32 s82, s82, 4096
    buffer_load_dwordx4 v[124:127], v144, s[40:43], s81 offen offset:3072 sc1
    s_add_u32 s81, s81, 4096
    buffer_load_dwordx4 v[128:131], v144, s[40:43], s83 offen offset:3072 sc1
    s_add_u32 s83, s83, 4096
    buffer_load_dwordx4 v[132:135], v144, s[40:43], s80 offen offset:0 sc1
    buffer_load_dwordx4 v[136:139], v144, s[40:43], s82 offen offset:0 sc1
    buffer_load_dwordx4 v[140:143], v144, s[40:43], s81 offen offset:0 sc1
    buffer_load_dwordx4 v[148:151], v144, s[40:43], s83 offen offset:0 sc1
    buffer_load_dwordx4 v[152:155], v144, s[40:43], s80 offen offset:1024 sc1
    buffer_load_dwordx4 v[156:159], v144, s[40:43], s82 offen offset:1024 sc1
    buffer_load_dwordx4 v[160:163], v144, s[40:43], s81 offen offset:1024 sc1
    s_setprio 0
    s_waitcnt vmcnt(21)
    v_mfma_f32_32x32x16_bf16 v[4:19], v[72:75], v[68:71], 0
    s_waitcnt vmcnt(20)
    v_mfma_f32_32x32x16_bf16 v[36:51], v[72:75], v[76:79], 0
    s_waitcnt vmcnt(19)
    v_mfma_f32_32x32x16_bf16 v[20:35], v[80:83], v[68:71], 0
    v_mfma_f32_32x32x16_bf16 v[52:67], v[80:83], v[76:79], 0
    buffer_load_dwordx4 v[68:71], v144, s[40:43], s83 offen offset:1024 sc1
    buffer_load_dwordx4 v[72:75], v144, s[40:43], s80 offen offset:2048 sc1
    buffer_load_dwordx4 v[76:79], v144, s[40:43], s82 offen offset:2048 sc1
    buffer_load_dwordx4 v[80:83], v144, s[40:43], s81 offen offset:2048 sc1
    s_waitcnt vmcnt(21)
    v_mfma_f32_32x32x16_bf16 v[4:19], v[88:91], v[84:87], v[4:19]
    s_waitcnt vmcnt(20)
    v_mfma_f32_32x32x16_bf16 v[36:51], v[88:91], v[92:95], v[36:51]
    s_waitcnt vmcnt(19)
    v_mfma_f32_32x32x16_bf16 v[20:35], v[96:99], v[84:87], v[20:35]
    v_mfma_f32_32x32x16_bf16 v[52:67], v[96:99], v[92:95], v[52:67]
    buffer_load_dwordx4 v[84:87], v144, s[40:43], s83 offen offset:2048 sc1
    buffer_load_dwordx4 v[88:91], v144, s[40:43], s80 offen offset:3072 sc1
    s_add_u32 s80, s80, 4096
    buffer_load_dwordx4 v[92:95], v144, s[40:43], s82 offen offset:3072 sc1
    s_add_u32 s82, s82, 4096
    buffer_load_dwordx4 v[96:99], v144, s[40:43], s81 offen offset:3072 sc1
    s_add_u32 s81, s81, 4096
    s_waitcnt vmcnt(21)
    v_mfma_f32_32x32x16_bf16 v[4:19], v[104:107], v[100:103], v[4:19]
    s_waitcnt vmcnt(20)
    v_mfma_f32_32x32x16_bf16 v[36:51], v[104:107], v[108:111], v[36:51]
    s_waitcnt vmcnt(19)
    v_mfma_f32_32x32x16_bf16 v[20:35], v[112:115], v[100:103], v[20:35]
    v_mfma_f32_32x32x16_bf16 v[52:67], v[112:115], v[108:111], v[52:67]
    buffer_load_dwordx4 v[100:103], v144, s[40:43], s83 offen offset:3072 sc1
    s_add_u32 s83, s83, 4096
    buffer_load_dwordx4 v[104:107], v144, s[40:43], s80 offen offset:0 sc1
    buffer_load_dwordx4 v[108:111], v144, s[40:43], s82 offen offset:0 sc1
    buffer_load_dwordx4 v[112:115], v144, s[40:43], s81 offen offset:0 sc1
    s_waitcnt vmcnt(21)
    v_mfma_f32_32x32x16_bf16 v[4:19], v[120:123], v[116:119], v[4:19]
    s_waitcnt vmcnt(20)
    v_mfma_f32_32x32x16_bf16 v[36:51], v[120:123], v[124:127], v[36:51]
    s_waitcnt vmcnt(19)
    v_mfma_f32_32x32x16_bf16 v[20:35], v[128:131], v[116:119], v[20:35]
    v_mfma_f32_32x32x16_bf16 v[52:67], v[128:131], v[124:127], v[52:67]
    buffer_load_dwordx4 v[116:119], v144, s[40:43], s83 offen offset:0 sc1
    buffer_load_dwordx4 v[120:123], v144, s[40:43], s80 offen offset:1024 sc1
    buffer_load_dwordx4 v[124:127], v144, s[40:43], s82 offen offset:1024 sc1
    buffer_load_dwordx4 v[128:131], v144, s[40:43], s81 offen offset:1024 sc1
    s_waitcnt vmcnt(21)
    v_mfma_f32_32x32x16_bf16 v[4:19], v[136:139], v[132:135], v[4:19]
    s_waitcnt vmcnt(20)
    v_mfma_f32_32x32x16_bf16 v[36:51], v[136:139], v[140:143], v[36:51]
    s_waitcnt vmcnt(19)
    v_mfma_f32_32x32x16_bf16 v[20:35], v[148:151], v[132:135], v[20:35]
    v_mfma_f32_32x32x16_bf16 v[52:67], v[148:151], v[140:143], v[52:67]
    buffer_load_dwordx4 v[132:135], v144, s[40:43], s83 offen offset:1024 sc1
    buffer_load_dwordx4 v[136:139], v144, s[40:43], s80 offen offset:2048 sc1
    buffer_load_dwordx4 v[140:143], v144, s[40:43], s82 offen offset:2048 sc1
    buffer_load_dwordx4 v[148:151], v144, s[40:43], s81 offen offset:2048 sc1
    s_waitcnt vmcnt(21)
    v_mfma_f32_32x32x16_bf16 v[4:19], v[156:159], v[152:155], v[4:19]
    s_waitcnt vmcnt(20)
    v_mfma_f32_32x32x16_bf16 v[36:51], v[156:159], v[160:163], v[36:51]
    s_waitcnt vmcnt(19)
    v_mfma_f32_32x32x16_bf16 v[20:35], v[68:71], v[152:155], v[20:35]
    v_mfma_f32_32x32x16_bf16 v[52:67], v[68:71], v[160:163], v[52:67]
    buffer_load_dwordx4 v[152:155], v144, s[40:43], s83 offen offset:2048 sc1
    buffer_load_dwordx4 v[156:159], v144, s[40:43], s80 offen offset:3072 sc1
    s_add_u32 s80, s80, 4096
    buffer_load_dwordx4 v[160:163], v144, s[40:43], s82 offen offset:3072 sc1
    s_add_u32 s82, s82, 4096
    buffer_load_dwordx4 v[68:71], v144, s[40:43], s81 offen offset:3072 sc1
    s_add_u32 s81, s81, 4096
    s_waitcnt vmcnt(21)
    v_mfma_f32_32x32x16_bf16 v[4:19], v[76:79], v[72:75], v[4:19]
    s_waitcnt vmcnt(20)
    v_mfma_f32_32x32x16_bf16 v[36:51], v[76:79], v[80:83], v[36:51]
    s_waitcnt vmcnt(19)
    v_mfma_f32_32x32x16_bf16 v[20:35], v[84:87], v[72:75], v[20:35]
    v_mfma_f32_32x32x16_bf16 v[52:67], v[84:87], v[80:83], v[52:67]
    buffer_load_dwordx4 v[72:75], v144, s[40:43], s83 offen offset:3072 sc1
    s_add_u32 s83, s83, 4096
    buffer_load_dwordx4 v[76:79], v144, s[40:43], s80 offen offset:0 sc1
    buffer_load_dwordx4 v[80:83], v144, s[40:43], s82 offen offset:0 sc1
    buffer_load_dwordx4 v[84:87], v144, s[40:43], s81 offen offset:0 sc1
    s_waitcnt vmcnt(21)
    v_mfma_f32_32x32x16_bf16 v[4:19], v[92:95], v[88:91], v[4:19]
    s_waitcnt vmcnt(20)
    v_mfma_f32_32x32x16_bf16 v[36:51], v[92:95], v[96:99], v[36:51]
    s_waitcnt vmcnt(19)
    v_mfma_f32_32x32x16_bf16 v[20:35], v[100:103], v[88:91], v[20:35]
    v_mfma_f32_32x32x16_bf16 v[52:67], v[100:103], v[96:99], v[52:67]
    buffer_load_dwordx4 v[88:91], v144, s[40:43], s83 offen offset:0 sc1
    buffer_load_dwordx4 v[92:95], v144, s[40:43], s80 offen offset:1024 sc1
    buffer_load_dwordx4 v[96:99], v144, s[40:43], s82 offen offset:1024 sc1
    buffer_load_dwordx4 v[100:103], v144, s[40:43], s81 offen offset:1024 sc1
    s_waitcnt vmcnt(21)
    v_mfma_f32_32x32x16_bf16 v[4:19], v[108:111], v[104:107], v[4:19]
    s_waitcnt vmcnt(20)
    v_mfma_f32_32x32x16_bf16 v[36:51], v[108:111], v[112:115], v[36:51]
    s_waitcnt vmcnt(19)
    v_mfma_f32_32x32x16_bf16 v[20:35], v[116:119], v[104:107], v[20:35]
    v_mfma_f32_32x32x16_bf16 v[52:67], v[116:119], v[112:115], v[52:67]
    buffer_load_dwordx4 v[104:107], v144, s[40:43], s83 offen offset:1024 sc1
    buffer_load_dwordx4 v[108:111], v144, s[40:43], s80 offen offset:2048 sc1
    buffer_load_dwordx4 v[112:115], v144, s[40:43], s82 offen offset:2048 sc1
    buffer_load_dwordx4 v[116:119], v144, s[40:43], s81 offen offset:2048 sc1
    s_waitcnt vmcnt(21)
    v_mfma_f32_32x32x16_bf16 v[4:19], v[124:127], v[120:123], v[4:19]
    s_waitcnt vmcnt(20)
    v_mfma_f32_32x32x16_bf16 v[36:51], v[124:127], v[128:131], v[36:51]
    s_waitcnt vmcnt(19)
    v_mfma_f32_32x32x16_bf16 v[20:35], v[132:135], v[120:123], v[20:35]
    v_mfma_f32_32x32x16_bf16 v[52:67], v[132:135], v[128:131], v[52:67]
    buffer_load_dwordx4 v[120:123], v144, s[40:43], s83 offen offset:2048 sc1
    buffer_load_dwordx4 v[124:127], v144, s[40:43], s80 offen offset:3072 sc1
    s_add_u32 s80, s80, 4096
    buffer_load_dwordx4 v[128:131], v144, s[40:43], s82 offen offset:3072 sc1
    s_add_u32 s82, s82, 4096
    buffer_load_dwordx4 v[132:135], v144, s[40:43], s81 offen offset:3072 sc1
    s_add_u32 s81, s81, 4096
    s_waitcnt vmcnt(21)
    v_mfma_f32_32x32x16_bf16 v[4:19], v[140:143], v[136:139], v[4:19]
    s_waitcnt vmcnt(20)
    v_mfma_f32_32x32x16_bf16 v[36:51], v[140:143], v[148:151], v[36:51]
    s_waitcnt vmcnt(19)
    v_mfma_f32_32x32x16_bf16 v[20:35], v[152:155], v[136:139], v[20:35]
    v_mfma_f32_32x32x16_bf16 v[52:67], v[152:155], v[148:151], v[52:67]
    buffer_load_dwordx4 v[136:139], v144, s[40:43], s83 offen offset:3072 sc1
    s_add_u32 s83, s83, 4096
    buffer_load_dwordx4 v[140:143], v144, s[40:43], s80 offen offset:0 sc1
    buffer_load_dwordx4 v[148:151], v144, s[40:43], s82 offen offset:0 sc1
    buffer_load_dwordx4 v[152:155], v144, s[40:43], s81 offen offset:0 sc1
    s_waitcnt vmcnt(21)
    v_mfma_f32_32x32x16_bf16 v[4:19], v[160:163], v[156:159], v[4:19]
    s_waitcnt vmcnt(20)
    v_mfma_f32_32x32x16_bf16 v[36:51], v[160:163], v[68:71], v[36:51]
    s_waitcnt vmcnt(19)
    v_mfma_f32_32x32x16_bf16 v[20:35], v[72:75], v[156:159], v[20:35]
    v_mfma_f32_32x32x16_bf16 v[52:67], v[72:75], v[68:71], v[52:67]
    buffer_load_dwordx4 v[156:159], v144, s[40:43], s83 offen offset:0 sc1
    buffer_load_dwordx4 v[160:163], v144, s[40:43], s80 offen offset:1024 sc1
    buffer_load_dwordx4 v[68:71], v144, s[40:43], s82 offen offset:1024 sc1
    buffer_load_dwordx4 v[72:75], v144, s[40:43], s81 offen offset:1024 sc1
    s_waitcnt vmcnt(21)
    v_mfma_f32_32x32x16_bf16 v[4:19], v[80:83], v[76:79], v[4:19]
    s_waitcnt vmcnt(20)
    v_mfma_f32_32x32x16_bf16 v[36:51], v[80:83], v[84:87], v[36:51]
    s_waitcnt vmcnt(19)
    v_mfma_f32_32x32x16_bf16 v[20:35], v[88:91], v[76:79], v[20:35]
    v_mfma_f32_32x32x16_bf16 v[52:67], v[88:91], v[84:87], v[52:67]
    buffer_load_dwordx4 v[76:79], v144, s[40:43], s83 offen offset:1024 sc1
    buffer_load_dwordx4 v[80:83], v144, s[40:43], s80 offen offset:2048 sc1
    buffer_load_dwordx4 v[84:87], v144, s[40:43], s82 offen offset:2048 sc1
    buffer_load_dwordx4 v[88:91], v144, s[40:43], s81 offen offset:2048 sc1
    s_waitcnt vmcnt(21)
    v_mfma_f32_32x32x16_bf16 v[4:19], v[96:99], v[92:95], v[4:19]
    s_waitcnt vmcnt(20)
    v_mfma_f32_32x32x16_bf16 v[36:51], v[96:99], v[100:103], v[36:51]
    s_waitcnt vmcnt(19)
    v_mfma_f32_32x32x16_bf16 v[20:35], v[104:107], v[92:95], v[20:35]
    v_mfma_f32_32x32x16_bf16 v[52:67], v[104:107], v[100:103], v[52:67]
    buffer_load_dwordx4 v[92:95], v144, s[40:43], s83 offen offset:2048 sc1
    buffer_load_dwordx4 v[96:99], v144, s[40:43], s80 offen offset:3072 sc1
    s_add_u32 s80, s80, 4096
    buffer_load_dwordx4 v[100:103], v144, s[40:43], s82 offen offset:3072 sc1
    s_add_u32 s82, s82, 4096
    buffer_load_dwordx4 v[104:107], v144, s[40:43], s81 offen offset:3072 sc1
    s_add_u32 s81, s81, 4096
    s_waitcnt vmcnt(21)
    v_mfma_f32_32x32x16_bf16 v[4:19], v[112:115], v[108:111], v[4:19]
    s_waitcnt vmcnt(20)
    v_mfma_f32_32x32x16_bf16 v[36:51], v[112:115], v[116:119], v[36:51]
    s_waitcnt vmcnt(19)
    v_mfma_f32_32x32x16_bf16 v[20:35], v[120:123], v[108:111], v[20:35]
    v_mfma_f32_32x32x16_bf16 v[52:67], v[120:123], v[116:119], v[52:67]
    buffer_load_dwordx4 v[108:111], v144, s[40:43], s83 offen offset:3072 sc1
    s_add_u32 s83, s83, 4096
    buffer_load_dwordx4 v[112:115], v144, s[40:43], s80 offen offset:0 sc1
    buffer_load_dwordx4 v[116:119], v144, s[40:43], s82 offen offset:0 sc1
    buffer_load_dwordx4 v[120:123], v144, s[40:43], s81 offen offset:0 sc1
    s_waitcnt vmcnt(21)
    v_mfma_f32_32x32x16_bf16 v[4:19], v[128:131], v[124:127], v[4:19]
    s_waitcnt vmcnt(20)
    v_mfma_f32_32x32x16_bf16 v[36:51], v[128:131], v[132:135], v[36:51]
    s_waitcnt vmcnt(19)
    v_mfma_f32_32x32x16_bf16 v[20:35], v[136:139], v[124:127], v[20:35]
    v_mfma_f32_32x32x16_bf16 v[52:67], v[136:139], v[132:135], v[52:67]
    buffer_load_dwordx4 v[124:127], v144, s[40:43], s83 offen offset:0 sc1
    buffer_load_dwordx4 v[128:131], v144, s[40:43], s80 offen offset:1024 sc1
    buffer_load_dwordx4 v[132:135], v144, s[40:43], s82 offen offset:1024 sc1
    buffer_load_dwordx4 v[136:139], v144, s[40:43], s81 offen offset:1024 sc1
    s_waitcnt vmcnt(21)
    v_mfma_f32_32x32x16_bf16 v[4:19], v[148:151], v[140:143], v[4:19]
    s_waitcnt vmcnt(20)
    v_mfma_f32_32x32x16_bf16 v[36:51], v[148:151], v[152:155], v[36:51]
    s_waitcnt vmcnt(19)
    v_mfma_f32_32x32x16_bf16 v[20:35], v[156:159], v[140:143], v[20:35]
    v_mfma_f32_32x32x16_bf16 v[52:67], v[156:159], v[152:155], v[52:67]
    buffer_load_dwordx4 v[140:143], v144, s[40:43], s83 offen offset:1024 sc1
    buffer_load_dwordx4 v[148:151], v144, s[40:43], s80 offen offset:2048 sc1
    buffer_load_dwordx4 v[152:155], v144, s[40:43], s82 offen offset:2048 sc1
    buffer_load_dwordx4 v[156:159], v144, s[40:43], s81 offen offset:2048 sc1
    s_waitcnt vmcnt(21)
    v_mfma_f32_32x32x16_bf16 v[4:19], v[68:71], v[160:163], v[4:19]
    s_waitcnt vmcnt(20)
    v_mfma_f32_32x32x16_bf16 v[36:51], v[68:71], v[72:75], v[36:51]
    s_waitcnt vmcnt(19)
    v_mfma_f32_32x32x16_bf16 v[20:35], v[76:79], v[160:163], v[20:35]
    v_mfma_f32_32x32x16_bf16 v[52:67], v[76:79], v[72:75], v[52:67]
    buffer_load_dwordx4 v[160:163], v144, s[40:43], s83 offen offset:2048 sc1
    buffer_load_dwordx4 v[68:71], v144, s[40:43], s80 offen offset:3072 sc1
    s_add_u32 s80, s80, 4096
    buffer_load_dwordx4 v[72:75], v144, s[40:43], s82 offen offset:3072 sc1
    s_add_u32 s82, s82, 4096
    buffer_load_dwordx4 v[76:79], v144, s[40:43], s81 offen offset:3072 sc1
    s_add_u32 s81, s81, 4096
    s_waitcnt vmcnt(21)
    v_mfma_f32_32x32x16_bf16 v[4:19], v[84:87], v[80:83], v[4:19]
    s_waitcnt vmcnt(20)
    v_mfma_f32_32x32x16_bf16 v[36:51], v[84:87], v[88:91], v[36:51]
    s_waitcnt vmcnt(19)
    v_mfma_f32_32x32x16_bf16 v[20:35], v[92:95], v[80:83], v[20:35]
    v_mfma_f32_32x32x16_bf16 v[52:67], v[92:95], v[88:91], v[52:67]
    buffer_load_dwordx4 v[80:83], v144, s[40:43], s83 offen offset:3072 sc1
    s_add_u32 s83, s83, 4096
    buffer_load_dwordx4 v[84:87], v144, s[40:43], s80 offen offset:0 sc1
    buffer_load_dwordx4 v[88:91], v144, s[40:43], s82 offen offset:0 sc1
    buffer_load_dwordx4 v[92:95], v144, s[40:43], s81 offen offset:0 sc1
    s_waitcnt vmcnt(21)
    v_mfma_f32_32x32x16_bf16 v[4:19], v[100:103], v[96:99], v[4:19]
    s_waitcnt vmcnt(20)
    v_mfma_f32_32x32x16_bf16 v[36:51], v[100:103], v[104:107], v[36:51]
    s_waitcnt vmcnt(19)
    v_mfma_f32_32x32x16_bf16 v[20:35], v[108:111], v[96:99], v[20:35]
    v_mfma_f32_32x32x16_bf16 v[52:67], v[108:111], v[104:107], v[52:67]
    buffer_load_dwordx4 v[96:99], v144, s[40:43], s83 offen offset:0 sc1
    buffer_load_dwordx4 v[100:103], v144, s[40:43], s80 offen offset:1024 sc1
    buffer_load_dwordx4 v[104:107], v144, s[40:43], s82 offen offset:1024 sc1
    buffer_load_dwordx4 v[108:111], v144, s[40:43], s81 offen offset:1024 sc1
    s_waitcnt vmcnt(21)
    v_mfma_f32_32x32x16_bf16 v[4:19], v[116:119], v[112:115], v[4:19]
    s_waitcnt vmcnt(20)
    v_mfma_f32_32x32x16_bf16 v[36:51], v[116:119], v[120:123], v[36:51]
    s_waitcnt vmcnt(19)
    v_mfma_f32_32x32x16_bf16 v[20:35], v[124:127], v[112:115], v[20:35]
    v_mfma_f32_32x32x16_bf16 v[52:67], v[124:127], v[120:123], v[52:67]
    buffer_load_dwordx4 v[112:115], v144, s[40:43], s83 offen offset:1024 sc1
    buffer_load_dwordx4 v[116:119], v144, s[40:43], s80 offen offset:2048 sc1
    buffer_load_dwordx4 v[120:123], v144, s[40:43], s82 offen offset:2048 sc1
    buffer_load_dwordx4 v[124:127], v144, s[40:43], s81 offen offset:2048 sc1
    s_waitcnt vmcnt(21)
    v_mfma_f32_32x32x16_bf16 v[4:19], v[132:135], v[128:131], v[4:19]
    s_waitcnt vmcnt(20)
    v_mfma_f32_32x32x16_bf16 v[36:51], v[132:135], v[136:139], v[36:51]
    s_waitcnt vmcnt(19)
    v_mfma_f32_32x32x16_bf16 v[20:35], v[140:143], v[128:131], v[20:35]
    v_mfma_f32_32x32x16_bf16 v[52:67], v[140:143], v[136:139], v[52:67]
    buffer_load_dwordx4 v[128:131], v144, s[40:43], s83 offen offset:2048 sc1
    buffer_load_dwordx4 v[132:135], v144, s[40:43], s80 offen offset:3072 sc1
    s_add_u32 s80, s80, 4096
    buffer_load_dwordx4 v[136:139], v144, s[40:43], s82 offen offset:3072 sc1
    s_add_u32 s82, s82, 4096
    buffer_load_dwordx4 v[140:143], v144, s[40:43], s81 offen offset:3072 sc1
    s_add_u32 s81, s81, 4096
    s_waitcnt vmcnt(21)
    v_mfma_f32_32x32x16_bf16 v[4:19], v[152:155], v[148:151], v[4:19]
    s_waitcnt vmcnt(20)
    v_mfma_f32_32x32x16_bf16 v[36:51], v[152:155], v[156:159], v[36:51]
    s_waitcnt vmcnt(19)
    v_mfma_f32_32x32x16_bf16 v[20:35], v[160:163], v[148:151], v[20:35]
    v_mfma_f32_32x32x16_bf16 v[52:67], v[160:163], v[156:159], v[52:67]
    buffer_load_dwordx4 v[148:151], v144, s[40:43], s83 offen offset:3072 sc1
    s_add_u32 s83, s83, 4096
    s_waitcnt vmcnt(18)
    v_mfma_f32_32x32x16_bf16 v[4:19], v[72:75], v[68:71], v[4:19]
    s_waitcnt vmcnt(17)
    v_mfma_f32_32x32x16_bf16 v[36:51], v[72:75], v[76:79], v[36:51]
    s_waitcnt vmcnt(16)
    v_mfma_f32_32x32x16_bf16 v[20:35], v[80:83], v[68:71], v[20:35]
    v_mfma_f32_32x32x16_bf16 v[52:67], v[80:83], v[76:79], v[52:67]
    s_setprio 3
    s_waitcnt vmcnt(14)
    v_mfma_f32_32x32x16_bf16 v[4:19], v[88:91], v[84:87], v[4:19]
    s_waitcnt vmcnt(13)
    v_mfma_f32_32x32x16_bf16 v[36:51], v[88:91], v[92:95], v[36:51]
    s_waitcnt vmcnt(12)
    v_mfma_f32_32x32x16_bf16 v[20:35], v[96:99], v[84:87], v[20:35]
    v_mfma_f32_32x32x16_bf16 v[52:67], v[96:99], v[92:95], v[52:67]
    s_waitcnt vmcnt(10)
    v_mfma_f32_32x32x16_bf16 v[4:19], v[104:107], v[100:103], v[4:19]
    s_waitcnt vmcnt(9)
    v_mfma_f32_32x32x16_bf16 v[36:51], v[104:107], v[108:111], v[36:51]
    s_waitcnt vmcnt(8)
    v_mfma_f32_32x32x16_bf16 v[20:35], v[112:115], v[100:103], v[20:35]
    v_mfma_f32_32x32x16_bf16 v[52:67], v[112:115], v[108:111], v[52:67]
    s_waitcnt vmcnt(6)
    v_mfma_f32_32x32x16_bf16 v[4:19], v[120:123], v[116:119], v[4:19]
    s_waitcnt vmcnt(5)
    v_mfma_f32_32x32x16_bf16 v[36:51], v[120:123], v[124:127], v[36:51]
    s_waitcnt vmcnt(4)
    v_mfma_f32_32x32x16_bf16 v[20:35], v[128:131], v[116:119], v[20:35]
    v_mfma_f32_32x32x16_bf16 v[52:67], v[128:131], v[124:127], v[52:67]
    s_waitcnt vmcnt(0)
    v_mfma_f32_32x32x16_bf16 v[20:35], v[148:151], v[132:135], v[20:35]
    v_mfma_f32_32x32x16_bf16 v[36:51], v[136:139], v[140:143], v[36:51]
    v_mfma_f32_32x32x16_bf16 v[52:67], v[148:151], v[140:143], v[52:67]
    v_mfma_f32_32x32x16_bf16 v[4:19], v[136:139], v[132:135], v[4:19]
    s_lshl_b32 s59, s72, 12
    s_add_u32 s59, s59, 133120
    v_add_u32 v68, s59, v144
    v_add_u32 v69, 80, v145
    v_add_u32 v145, 32, v145
    s_nop 3
    ds_write_b128 v68, v[20:23] offset:0
    ds_write_b128 v68, v[24:27] offset:1024
    ds_write_b128 v68, v[28:31] offset:2048
    ds_write_b128 v68, v[32:35] offset:3072
    v_mov_b32 v73, 1
    ds_write_b32 v69, v73
    s_xor_b32 s60, s72, 1
    s_lshl_b32 s60, s60, 12
    s_add_u32 s60, s60, 133120
    v_add_u32 v70, s60, v144
    v_xor_b32 v71, 4, v69
.Lxw28:
    ds_read_b32 v72, v71
    s_waitcnt lgkmcnt(0)
    v_readfirstlane_b32 s59, v72
    s_cmp_ge_u32 s59, 1
    s_cbranch_scc1 .Lxok29
    s_sleep 1
    s_branch .Lxw28
.Lxok29:
    ds_read_b128 v[76:79], v70 offset:0
    ds_read_b128 v[80:83], v70 offset:1024
    ds_read_b128 v[84:87], v70 offset:2048
    ds_read_b128 v[88:91], v70 offset:3072
    v_mov_b32 v73, 2
    ds_write_b32 v69, v73
    s_waitcnt lgkmcnt(1)
    v_add_f32 v4, v4, v76
    v_add_f32 v5, v5, v77
    v_add_f32 v6, v6, v78
    v_add_f32 v7, v7, v79
    v_add_f32 v8, v8, v80
    v_add_f32 v9, v9, v81
    v_add_f32 v10, v10, v82
    v_add_f32 v11, v11, v83
    v_add_f32 v12, v12, v84
    v_add_f32 v13, v13, v85
    v_add_f32 v14, v14, v86
    v_add_f32 v15, v15, v87
    v_add_f32 v16, v16, v88
    v_add_f32 v17, v17, v89
    v_add_f32 v18, v18, v90
    v_add_f32 v19, v19, v91
.Lxw30:
    ds_read_b32 v72, v71
    s_waitcnt lgkmcnt(0)
    v_readfirstlane_b32 s59, v72
    s_cmp_ge_u32 s59, 2
    s_cbranch_scc1 .Lxok31
    s_sleep 1
    s_branch .Lxw30
.Lxok31:
    ds_write_b128 v68, v[36:39] offset:0
    ds_write_b128 v68, v[40:43] offset:1024
    ds_write_b128 v68, v[44:47] offset:2048
    ds_write_b128 v68, v[48:51] offset:3072
    v_mov_b32 v73, 3
    ds_write_b32 v69, v73
    s_xor_b32 s60, s72, 2
    s_lshl_b32 s60, s60, 12
    s_add_u32 s60, s60, 133120
    v_add_u32 v70, s60, v144
    v_xor_b32 v71, 8, v69
.Lxw32:
    ds_read_b32 v72, v71
    s_waitcnt lgkmcnt(0)
    v_readfirstlane_b32 s59, v72
    s_cmp_ge_u32 s59, 3
    s_cbranch_scc1 .Lxok33
    s_sleep 1
    s_branch .Lxw32
.Lxok33:
    ds_read_b128 v[76:79], v70 offset:0
    ds_read_b128 v[80:83], v70 offset:1024
    ds_read_b128 v[84:87], v70 offset:2048
    ds_read_b128 v[88:91], v70 offset:3072
    v_mov_b32 v73, 4
    ds_write_b32 v69, v73
    s_waitcnt lgkmcnt(1)
    v_add_f32 v4, v4, v76
    v_add_f32 v5, v5, v77
    v_add_f32 v6, v6, v78
    v_add_f32 v7, v7, v79
    v_add_f32 v8, v8, v80
    v_add_f32 v9, v9, v81
    v_add_f32 v10, v10, v82
    v_add_f32 v11, v11, v83
    v_add_f32 v12, v12, v84
    v_add_f32 v13, v13, v85
    v_add_f32 v14, v14, v86
    v_add_f32 v15, v15, v87
    v_add_f32 v16, v16, v88
    v_add_f32 v17, v17, v89
    v_add_f32 v18, v18, v90
    v_add_f32 v19, v19, v91
.Lxw34:
    ds_read_b32 v72, v71
    s_waitcnt lgkmcnt(0)
    v_readfirstlane_b32 s59, v72
    s_cmp_ge_u32 s59, 4
    s_cbranch_scc1 .Lxok35
    s_sleep 1
    s_branch .Lxw34
.Lxok35:
    ds_write_b128 v68, v[52:55] offset:0
    ds_write_b128 v68, v[56:59] offset:1024
    ds_write_b128 v68, v[60:63] offset:2048
    ds_write_b128 v68, v[64:67] offset:3072
    v_mov_b32 v73, 5
    ds_write_b32 v69, v73
    s_xor_b32 s60, s72, 3
    s_lshl_b32 s60, s60, 12
    s_add_u32 s60, s60, 133120
    v_add_u32 v70, s60, v144
    v_xor_b32 v71, 12, v69
.Lxw36:
    ds_read_b32 v72, v71
    s_waitcnt lgkmcnt(0)
    v_readfirstlane_b32 s59, v72
    s_cmp_ge_u32 s59, 5
    s_cbranch_scc1 .Lxok37
    s_sleep 1
    s_branch .Lxw36
.Lxok37:
    ds_read_b128 v[76:79], v70 offset:0
    ds_read_b128 v[80:83], v70 offset:1024
    ds_read_b128 v[84:87], v70 offset:2048
    ds_read_b128 v[88:91], v70 offset:3072
    v_mov_b32 v73, 6
    ds_write_b32 v69, v73
    s_waitcnt lgkmcnt(1)
    v_add_f32 v4, v4, v76
    v_add_f32 v5, v5, v77
    v_add_f32 v6, v6, v78
    v_add_f32 v7, v7, v79
    v_add_f32 v8, v8, v80
    v_add_f32 v9, v9, v81
    v_add_f32 v10, v10, v82
    v_add_f32 v11, v11, v83
    v_add_f32 v12, v12, v84
    v_add_f32 v13, v13, v85
    v_add_f32 v14, v14, v86
    v_add_f32 v15, v15, v87
    v_add_f32 v16, v16, v88
    v_add_f32 v17, v17, v89
    v_add_f32 v18, v18, v90
    v_add_f32 v19, v19, v91
    s_lshl_b32 s59, s72, 11
    s_add_u32 s59, s59, 151552
    v_add_u32 v68, s59, v144
    v_mul_f32 v4, v147, v4
    v_mul_f32 v5, v147, v5
    v_cvt_pk_bf16_f32 v32, v4, v5
    v_mul_f32 v6, v147, v6
    v_mul_f32 v7, v147, v7
    v_cvt_pk_bf16_f32 v33, v6, v7
    v_mul_f32 v8, v147, v8
    v_mul_f32 v9, v147, v9
    v_cvt_pk_bf16_f32 v34, v8, v9
    v_mul_f32 v10, v147, v10
    v_mul_f32 v11, v147, v11
    v_cvt_pk_bf16_f32 v35, v10, v11
    v_mul_f32 v12, v147, v12
    v_mul_f32 v13, v147, v13
    v_cvt_pk_bf16_f32 v36, v12, v13
    v_mul_f32 v14, v147, v14
    v_mul_f32 v15, v147, v15
    v_cvt_pk_bf16_f32 v37, v14, v15
    v_mul_f32 v16, v147, v16
    v_mul_f32 v17, v147, v17
    v_cvt_pk_bf16_f32 v38, v16, v17
    v_mul_f32 v18, v147, v18
    v_mul_f32 v19, v147, v19
    v_cvt_pk_bf16_f32 v39, v18, v19
    ds_write_b128 v68, v[32:35]
    ds_write_b128 v68, v[36:39] offset:1024
    v_mov_b32 v4, 2
    ds_write_b32 v145, v4
    s_setprio 0
    v_mov_b32 v2, 160288
.Llw38:
    ds_read_b128 v[16:19], v2
    s_waitcnt lgkmcnt(0)
    v_and_b32 v16, v16, v17
    v_and_b32 v18, v18, v19
    v_and_b32 v16, v16, v18
    s_nop 0
    v_readfirstlane_b32 s59, v16
    s_cmp_eq_u32 s59, 2
    s_cbranch_scc1 .Llwok39
    s_sleep 2
    s_branch .Llw38
.Llwok39:
    s_mov_b32 s73, 1
    s_branch .Lph3
.Lend:
    s_endpgm
.section .rodata,"a"
.p2align 6
.amdhsa_kernel recurrent_scan__grouped_kv_mqa__glu_gated_reglu__prompt_kernel
  .amdhsa_next_free_vgpr 168
  .amdhsa_next_free_sgpr 100
  .amdhsa_accum_offset 168
  .amdhsa_group_segment_fixed_size 0
  .amdhsa_kernarg_size 96
  .amdhsa_user_sgpr_count 2
  .amdhsa_user_sgpr_kernarg_segment_ptr 1
  .amdhsa_system_sgpr_workgroup_id_x 1
.end_amdhsa_kernel
```
